```python
import torch

def _softmax(x, axis=-1):
    return torch.softmax(x, dim=axis)
def _gelu(x):
    return torch.nn.functional.gelu(x, approximate="tanh")
def _silu(x):
    return torch.nn.functional.silu(x)
def _sigmoid(x):
    return torch.sigmoid(x)
def _layernorm(x, axis=-1, eps=1e-5):
    m = x.mean(dim=axis, keepdim=True)
    v = x.var(dim=axis, keepdim=True, unbiased=False)
    return (x - m) / torch.sqrt(v + eps)
def _scatter_add(tgt, idx, src, axis=0):
    return tgt.clone().index_add_(axis, idx, src)
def _segment_sum(src, seg, n):
    out = torch.zeros((n,) + src.shape[1:], dtype=src.dtype)
    return out.index_add_(0, seg, src)
def _pad(x, pw):
    flat = tuple(v for pair in reversed(pw) for v in pair)
    return torch.nn.functional.pad(x, flat)

kernel_name = 'gated_mix__gqa_block_cached__dense_activation_gelu__decode'

def setup_inputs():

    _w = (lambda a: (lambda t: t.to(torch.bfloat16) if t.is_floating_point() else t)(torch.as_tensor(a)))
    def _A_setup():
        B, Sq, D = 1, 1, 448
        Hq, Hkv, Sk, Dh = 16, 8, 65536, 256
        assert Hq % Hkv == 0, (Hq, Hkv)
        return {
            "x": _w((lambda *s: torch.randn(*s, dtype=torch.bfloat16) * 0.05)(B, Sq, D)),
            "k_cache": _w((lambda *s: torch.randn(*s, dtype=torch.bfloat16) * 6.4)(B, Hkv, Sk, Dh)),
            "v_cache": _w((lambda *s: torch.randn(*s, dtype=torch.bfloat16) * 0.4)(B, Hkv, Sk, Dh)),
            "wq": _w((lambda *s: torch.randn(*s, dtype=torch.bfloat16) * 6.4)(D, Hq * Dh) * (D ** -0.5)),
            "wo": _w((lambda *s: torch.randn(*s, dtype=torch.bfloat16) * 0.4)(Hq * Dh, D) * ((Hq * Dh) ** -0.5)),
        }
    _A_in = _A_setup()

    def _B_setup():
        B, S, D, F = 1, 1, 448, 1792
        return {
            "x": _w((lambda *s: torch.randn(*s, dtype=torch.bfloat16) * 0.05)(B, S, D)),
            "w1": _w((lambda *s: torch.randn(*s, dtype=torch.bfloat16) * 3.2)(D, F) * (D ** -0.5)),
            "b1": _w((lambda *s: torch.randn(*s, dtype=torch.bfloat16) * 3.2)(F) * 0.01),
            "w2": _w((lambda *s: torch.randn(*s, dtype=torch.bfloat16) * 0.2)(F, D) * (F ** -0.5)),
            "b2": _w((lambda *s: torch.randn(*s, dtype=torch.bfloat16) * 0.4)(D) * 0.01),
        }
    _B_in = _B_setup()

    return {
        "A_x": _A_in["x"],
        "A_k_cache": _A_in["k_cache"],
        "A_v_cache": _A_in["v_cache"],
        "A_wq": _A_in["wq"],
        "A_wo": _A_in["wo"],
        "B_x": _B_in["x"],
        "B_w1": _B_in["w1"],
        "B_b1": _B_in["b1"],
        "B_w2": _B_in["w2"],
        "B_b2": _B_in["b2"],
        "gate_w": _w((lambda *s: torch.randn(*s, dtype=torch.bfloat16) * 0.05)(448) * 16.0),
    }

def reference(A_x, A_k_cache, A_v_cache, A_wq, A_wo, B_x, B_w1, B_b1, B_w2, B_b2, gate_w):
    def _A_ref(x, k_cache, v_cache, wq, wo):
        B, Sq, D = x.shape
        Hq, Dh = 16, 256
        Hkv = k_cache.shape[1]
        rep = Hq // Hkv
        q = (lambda x, *d: x.permute(*d))((x @ wq).reshape(B, Sq, Hq, Dh), 0, 2, 1, 3)
        k = (lambda x, n, axis: torch.repeat_interleave(x, n, dim=axis))(k_cache, rep, axis=1)
        v = (lambda x, n, axis: torch.repeat_interleave(x, n, dim=axis))(v_cache, rep, axis=1)
        scores = torch.einsum("bhqd,bhkd->bhqk", q, k) * (Dh ** -0.5)
        p = _softmax(scores, axis=-1)
        o = torch.einsum("bhqk,bhkd->bhqd", p, v)
        return (lambda x, *d: x.permute(*d))(o, 0, 2, 1, 3).reshape(B, Sq, Hq * Dh) @ wo

    def _B_ref(x, w1, b1, w2, b2):
        h = torch.einsum("bsd,df->bsf", x, w1) + b1
        h = _gelu(h)
        return torch.einsum("bsf,fd->bsd", h, w2) + b2

    x = A_x
    g = _sigmoid((x * gate_w).sum(-1, keepdims=True))
    a = _A_ref(x, A_k_cache, A_v_cache, A_wq, A_wo)
    b = _B_ref(x, B_w1, B_b1, B_w2, B_b2)
    return g * a + (1 - g) * b
```

```asm
; @launch grid=(256,1,1) block=(256,1,1) lds=139264
.amdgcn_target "amdgcn-amd-amdhsa--gfx950"
.text
.globl gated_mix__gqa_block_cached__dense_activation_gelu__decode_kernel
.p2align 8
.type gated_mix__gqa_block_cached__dense_activation_gelu__decode_kernel,@function
gated_mix__gqa_block_cached__dense_activation_gelu__decode_kernel:
    s_cmp_ge_u32 s2, 256
    s_cbranch_scc1 L_exit
    s_load_dwordx16 s[32:47], s[0:1], 0
    s_load_dwordx8 s[48:55], s[0:1], 64
    s_load_dwordx4 s[56:59], s[0:1], 96
    v_and_b32 v1, 63, v0
    v_lshrrev_b32 v2, 6, v0
    v_and_b32 v4, 15, v0
    v_readfirstlane_b32 s60, v2
    v_lshrrev_b32 v3, 4, v1
    s_lshr_b32 s61, s2, 3
    s_and_b32 s61, s61, 7
    s_and_b32 s62, s2, 7
    s_lshr_b32 s65, s2, 6
    s_lshl_b32 s65, s65, 3
    s_or_b32 s62, s62, s65
    s_mov_b32 s64, 0x3db8aa3b
    s_mov_b32 s82, 0x01000100
    s_mov_b32 s83, 0x03020302
    s_lshl_b32 s84, s61, 10
    s_add_u32 s84, s84, 81920
    s_and_b32 s85, s2, 8
    s_lshl_b32 s85, s85, 4
    s_mov_b32 s74, 0
    v_lshrrev_b32 v5, 1, v4
    v_and_b32 v5, 1, v5
    v_lshlrev_b32 v5, 4, v5
    v_mov_b32 v6, 0xffff
    v_lshlrev_b32 v6, v5, v6
    v_lshrrev_b32 v5, 2, v4
    v_cmp_eq_u32 vcc, 0, v5
    s_nop 1
    v_cndmask_b32 v8, 0, v6, vcc
    v_cmp_eq_u32 vcc, 1, v5
    s_nop 1
    v_cndmask_b32 v9, 0, v6, vcc
    v_cmp_eq_u32 vcc, 2, v5
    s_nop 1
    v_cndmask_b32 v10, 0, v6, vcc
    v_cmp_eq_u32 vcc, 3, v5
    s_nop 1
    v_cndmask_b32 v11, 0, v6, vcc
    v_lshlrev_b32 v12, 9, v4
    v_lshl_add_u32 v12, v3, 4, v12
    v_lshlrev_b32 v13, 11, v3
    v_lshl_add_u32 v13, v4, 4, v13
    s_waitcnt lgkmcnt(0)
    s_mov_b32 s12, s58
    s_mov_b32 s13, s59
    s_mov_b32 s14, 1073741824
    s_mov_b32 s15, 0x20000
    s_mov_b32 s16, s56
    s_mov_b32 s17, s57
    s_mov_b32 s18, 256
    s_mov_b32 s19, 0x20000
    s_cmp_ge_u32 s60, 2
    s_cbranch_scc1 L_helper
    s_lshl_b32 s65, s61, 25
    s_add_u32 s4, s34, s65
    s_addc_u32 s5, s35, 0
    s_mov_b32 s6, 0x2000000
    s_mov_b32 s7, 0x20000
    s_add_u32 s8, s36, s65
    s_addc_u32 s9, s37, 0
    s_mov_b32 s10, 0x2000000
    s_mov_b32 s11, 0x20000
    s_lshl_b32 s63, s62, 1
    s_add_u32 s63, s63, s60
    s_lshl_b32 s80, s63, 13
    s_barrier
    buffer_load_dwordx4 v[64:67], v12, s[4:7], s80 offen offset:0 nt
    buffer_load_dwordx4 v[68:71], v12, s[4:7], s80 offen offset:64 nt
    buffer_load_dwordx4 v[72:75], v12, s[4:7], s80 offen offset:128 nt
    buffer_load_dwordx4 v[76:79], v12, s[4:7], s80 offen offset:192 nt
    buffer_load_dwordx4 v[80:83], v12, s[4:7], s80 offen offset:256 nt
    buffer_load_dwordx4 v[84:87], v12, s[4:7], s80 offen offset:320 nt
    buffer_load_dwordx4 v[88:91], v12, s[4:7], s80 offen offset:384 nt
    buffer_load_dwordx4 v[92:95], v12, s[4:7], s80 offen offset:448 nt
    buffer_load_dwordx4 v[96:99], v13, s[8:11], s80 offen offset:0 nt
    buffer_load_dwordx4 v[100:103], v13, s[8:11], s80 offen offset:256 nt
    buffer_load_dwordx4 v[104:107], v13, s[8:11], s80 offen offset:512 nt
    buffer_load_dwordx4 v[108:111], v13, s[8:11], s80 offen offset:768 nt
    buffer_load_dwordx4 v[112:115], v13, s[8:11], s80 offen offset:1024 nt
    buffer_load_dwordx4 v[116:119], v13, s[8:11], s80 offen offset:1280 nt
    buffer_load_dwordx4 v[120:123], v13, s[8:11], s80 offen offset:1536 nt
    buffer_load_dwordx4 v[124:127], v13, s[8:11], s80 offen offset:1792 nt
    s_add_u32 s80, s80, 524288
    s_waitcnt vmcnt(8)
    buffer_load_dwordx4 v[128:131], v12, s[4:7], s80 offen offset:0 nt
    buffer_load_dwordx4 v[132:135], v12, s[4:7], s80 offen offset:64 nt
    buffer_load_dwordx4 v[136:139], v12, s[4:7], s80 offen offset:128 nt
    buffer_load_dwordx4 v[140:143], v12, s[4:7], s80 offen offset:192 nt
    buffer_load_dwordx4 v[144:147], v12, s[4:7], s80 offen offset:256 nt
    buffer_load_dwordx4 v[148:151], v12, s[4:7], s80 offen offset:320 nt
    buffer_load_dwordx4 v[152:155], v12, s[4:7], s80 offen offset:384 nt
    buffer_load_dwordx4 v[156:159], v12, s[4:7], s80 offen offset:448 nt
    s_waitcnt vmcnt(8)
    buffer_load_dwordx4 v[160:163], v13, s[8:11], s80 offen offset:0 nt
    buffer_load_dwordx4 v[164:167], v13, s[8:11], s80 offen offset:256 nt
    buffer_load_dwordx4 v[168:171], v13, s[8:11], s80 offen offset:512 nt
    buffer_load_dwordx4 v[172:175], v13, s[8:11], s80 offen offset:768 nt
    buffer_load_dwordx4 v[176:179], v13, s[8:11], s80 offen offset:1024 nt
    buffer_load_dwordx4 v[180:183], v13, s[8:11], s80 offen offset:1280 nt
    buffer_load_dwordx4 v[184:187], v13, s[8:11], s80 offen offset:1536 nt
    buffer_load_dwordx4 v[188:191], v13, s[8:11], s80 offen offset:1792 nt
    s_add_u32 s80, s80, 524288
    s_waitcnt vmcnt(8)
    buffer_load_dwordx4 v[192:195], v12, s[4:7], s80 offen offset:0 nt
    buffer_load_dwordx4 v[196:199], v12, s[4:7], s80 offen offset:64 nt
    buffer_load_dwordx4 v[200:203], v12, s[4:7], s80 offen offset:128 nt
    buffer_load_dwordx4 v[204:207], v12, s[4:7], s80 offen offset:192 nt
    buffer_load_dwordx4 v[208:211], v12, s[4:7], s80 offen offset:256 nt
    buffer_load_dwordx4 v[212:215], v12, s[4:7], s80 offen offset:320 nt
    buffer_load_dwordx4 v[216:219], v12, s[4:7], s80 offen offset:384 nt
    buffer_load_dwordx4 v[220:223], v12, s[4:7], s80 offen offset:448 nt
    s_waitcnt vmcnt(8)
    buffer_load_dwordx4 v[224:227], v13, s[8:11], s80 offen offset:0 nt
    buffer_load_dwordx4 v[228:231], v13, s[8:11], s80 offen offset:256 nt
    buffer_load_dwordx4 v[232:235], v13, s[8:11], s80 offen offset:512 nt
    buffer_load_dwordx4 v[236:239], v13, s[8:11], s80 offen offset:768 nt
    buffer_load_dwordx4 v[240:243], v13, s[8:11], s80 offen offset:1024 nt
    buffer_load_dwordx4 v[244:247], v13, s[8:11], s80 offen offset:1280 nt
    buffer_load_dwordx4 v[248:251], v13, s[8:11], s80 offen offset:1536 nt
    buffer_load_dwordx4 v[252:255], v13, s[8:11], s80 offen offset:1792 nt
    s_add_u32 s80, s80, 524288
    s_waitcnt vmcnt(8)
    buffer_load_dwordx4 a[0:3], v12, s[4:7], s80 offen offset:0 nt
    buffer_load_dwordx4 a[4:7], v12, s[4:7], s80 offen offset:64 nt
    buffer_load_dwordx4 a[8:11], v12, s[4:7], s80 offen offset:128 nt
    buffer_load_dwordx4 a[12:15], v12, s[4:7], s80 offen offset:192 nt
    buffer_load_dwordx4 a[16:19], v12, s[4:7], s80 offen offset:256 nt
    buffer_load_dwordx4 a[20:23], v12, s[4:7], s80 offen offset:320 nt
    buffer_load_dwordx4 a[24:27], v12, s[4:7], s80 offen offset:384 nt
    buffer_load_dwordx4 a[28:31], v12, s[4:7], s80 offen offset:448 nt
    s_waitcnt vmcnt(8)
    buffer_load_dwordx4 a[32:35], v13, s[8:11], s80 offen offset:0 nt
    buffer_load_dwordx4 a[36:39], v13, s[8:11], s80 offen offset:256 nt
    buffer_load_dwordx4 a[40:43], v13, s[8:11], s80 offen offset:512 nt
    buffer_load_dwordx4 a[44:47], v13, s[8:11], s80 offen offset:768 nt
    buffer_load_dwordx4 a[48:51], v13, s[8:11], s80 offen offset:1024 nt
    buffer_load_dwordx4 a[52:55], v13, s[8:11], s80 offen offset:1280 nt
    buffer_load_dwordx4 a[56:59], v13, s[8:11], s80 offen offset:1536 nt
    buffer_load_dwordx4 a[60:63], v13, s[8:11], s80 offen offset:1792 nt
    s_add_u32 s80, s80, 524288
    s_waitcnt vmcnt(8)
    buffer_load_dwordx4 a[64:67], v12, s[4:7], s80 offen offset:0 nt
    buffer_load_dwordx4 a[68:71], v12, s[4:7], s80 offen offset:64 nt
    buffer_load_dwordx4 a[72:75], v12, s[4:7], s80 offen offset:128 nt
    buffer_load_dwordx4 a[76:79], v12, s[4:7], s80 offen offset:192 nt
    buffer_load_dwordx4 a[80:83], v12, s[4:7], s80 offen offset:256 nt
    buffer_load_dwordx4 a[84:87], v12, s[4:7], s80 offen offset:320 nt
    buffer_load_dwordx4 a[88:91], v12, s[4:7], s80 offen offset:384 nt
    buffer_load_dwordx4 a[92:95], v12, s[4:7], s80 offen offset:448 nt
    s_waitcnt vmcnt(8)
    buffer_load_dwordx4 a[96:99], v13, s[8:11], s80 offen offset:0 nt
    buffer_load_dwordx4 a[100:103], v13, s[8:11], s80 offen offset:256 nt
    buffer_load_dwordx4 a[104:107], v13, s[8:11], s80 offen offset:512 nt
    buffer_load_dwordx4 a[108:111], v13, s[8:11], s80 offen offset:768 nt
    buffer_load_dwordx4 a[112:115], v13, s[8:11], s80 offen offset:1024 nt
    buffer_load_dwordx4 a[116:119], v13, s[8:11], s80 offen offset:1280 nt
    buffer_load_dwordx4 a[120:123], v13, s[8:11], s80 offen offset:1536 nt
    buffer_load_dwordx4 a[124:127], v13, s[8:11], s80 offen offset:1792 nt
    s_add_u32 s80, s80, 524288
    s_waitcnt vmcnt(8)
    buffer_load_dwordx4 a[128:131], v12, s[4:7], s80 offen offset:0 nt
    buffer_load_dwordx4 a[132:135], v12, s[4:7], s80 offen offset:64 nt
    buffer_load_dwordx4 a[136:139], v12, s[4:7], s80 offen offset:128 nt
    buffer_load_dwordx4 a[140:143], v12, s[4:7], s80 offen offset:192 nt
    buffer_load_dwordx4 a[144:147], v12, s[4:7], s80 offen offset:256 nt
    buffer_load_dwordx4 a[148:151], v12, s[4:7], s80 offen offset:320 nt
    buffer_load_dwordx4 a[152:155], v12, s[4:7], s80 offen offset:384 nt
    buffer_load_dwordx4 a[156:159], v12, s[4:7], s80 offen offset:448 nt
    s_waitcnt vmcnt(8)
    buffer_load_dwordx4 a[160:163], v13, s[8:11], s80 offen offset:0 nt
    buffer_load_dwordx4 a[164:167], v13, s[8:11], s80 offen offset:256 nt
    buffer_load_dwordx4 a[168:171], v13, s[8:11], s80 offen offset:512 nt
    buffer_load_dwordx4 a[172:175], v13, s[8:11], s80 offen offset:768 nt
    buffer_load_dwordx4 a[176:179], v13, s[8:11], s80 offen offset:1024 nt
    buffer_load_dwordx4 a[180:183], v13, s[8:11], s80 offen offset:1280 nt
    buffer_load_dwordx4 a[184:187], v13, s[8:11], s80 offen offset:1536 nt
    buffer_load_dwordx4 a[188:191], v13, s[8:11], s80 offen offset:1792 nt
    s_add_u32 s80, s80, 524288
    s_waitcnt vmcnt(8)
    buffer_load_dwordx4 a[192:195], v12, s[4:7], s80 offen offset:0 nt
    buffer_load_dwordx4 a[196:199], v12, s[4:7], s80 offen offset:64 nt
    buffer_load_dwordx4 a[200:203], v12, s[4:7], s80 offen offset:128 nt
    buffer_load_dwordx4 a[204:207], v12, s[4:7], s80 offen offset:192 nt
    buffer_load_dwordx4 a[208:211], v12, s[4:7], s80 offen offset:256 nt
    buffer_load_dwordx4 a[212:215], v12, s[4:7], s80 offen offset:320 nt
    buffer_load_dwordx4 a[216:219], v12, s[4:7], s80 offen offset:384 nt
    buffer_load_dwordx4 a[220:223], v12, s[4:7], s80 offen offset:448 nt
    s_waitcnt vmcnt(8)
    buffer_load_dwordx4 a[224:227], v13, s[8:11], s80 offen offset:0 nt
    buffer_load_dwordx4 a[228:231], v13, s[8:11], s80 offen offset:256 nt
    buffer_load_dwordx4 a[232:235], v13, s[8:11], s80 offen offset:512 nt
    buffer_load_dwordx4 a[236:239], v13, s[8:11], s80 offen offset:768 nt
    buffer_load_dwordx4 a[240:243], v13, s[8:11], s80 offen offset:1024 nt
    buffer_load_dwordx4 a[244:247], v13, s[8:11], s80 offen offset:1280 nt
    buffer_load_dwordx4 a[248:251], v13, s[8:11], s80 offen offset:1536 nt
    buffer_load_dwordx4 a[252:255], v13, s[8:11], s80 offen offset:1792 nt
    s_add_u32 s80, s80, 524288
    s_barrier
    s_mul_i32 s101, s60, 65536
    s_add_u32 s101, s101, 8192
    v_lshlrev_b32 v2, 4, v1
    v_add_u32 v2, s101, v2
    s_waitcnt vmcnt(8)
    s_add_u32 m0, s101, 0
    s_nop 0
    buffer_load_dwordx4 v12, s[4:7], s80 offen offset:0 nt lds
    s_add_u32 m0, s101, 960
    s_nop 0
    buffer_load_dwordx4 v12, s[4:7], s80 offen offset:64 nt lds
    s_add_u32 m0, s101, 1920
    s_nop 0
    buffer_load_dwordx4 v12, s[4:7], s80 offen offset:128 nt lds
    s_add_u32 m0, s101, 2880
    s_nop 0
    buffer_load_dwordx4 v12, s[4:7], s80 offen offset:192 nt lds
    s_add_u32 m0, s101, 3840
    s_nop 0
    buffer_load_dwordx4 v12, s[4:7], s80 offen offset:256 nt lds
    s_add_u32 m0, s101, 4800
    s_nop 0
    buffer_load_dwordx4 v12, s[4:7], s80 offen offset:320 nt lds
    s_add_u32 m0, s101, 5760
    s_nop 0
    buffer_load_dwordx4 v12, s[4:7], s80 offen offset:384 nt lds
    s_add_u32 m0, s101, 6720
    s_nop 0
    buffer_load_dwordx4 v12, s[4:7], s80 offen offset:448 nt lds
    s_waitcnt vmcnt(8)
    s_add_u32 m0, s101, 8192
    s_nop 0
    buffer_load_dwordx4 v13, s[8:11], s80 offen offset:0 nt lds
    s_add_u32 m0, s101, 8960
    s_nop 0
    buffer_load_dwordx4 v13, s[8:11], s80 offen offset:256 nt lds
    s_add_u32 m0, s101, 9728
    s_nop 0
    buffer_load_dwordx4 v13, s[8:11], s80 offen offset:512 nt lds
    s_add_u32 m0, s101, 10496
    s_nop 0
    buffer_load_dwordx4 v13, s[8:11], s80 offen offset:768 nt lds
    s_add_u32 m0, s101, 11264
    s_nop 0
    buffer_load_dwordx4 v13, s[8:11], s80 offen offset:1024 nt lds
    s_add_u32 m0, s101, 12032
    s_nop 0
    buffer_load_dwordx4 v13, s[8:11], s80 offen offset:1280 nt lds
    s_add_u32 m0, s101, 12800
    s_nop 0
    buffer_load_dwordx4 v13, s[8:11], s80 offen offset:1536 nt lds
    s_add_u32 m0, s101, 13568
    s_nop 0
    buffer_load_dwordx4 v13, s[8:11], s80 offen offset:1792 nt lds
    s_add_u32 s80, s80, 524288
    s_waitcnt vmcnt(8)
    s_add_u32 m0, s101, 16384
    s_nop 0
    buffer_load_dwordx4 v12, s[4:7], s80 offen offset:0 nt lds
    s_add_u32 m0, s101, 17344
    s_nop 0
    buffer_load_dwordx4 v12, s[4:7], s80 offen offset:64 nt lds
    s_add_u32 m0, s101, 18304
    s_nop 0
    buffer_load_dwordx4 v12, s[4:7], s80 offen offset:128 nt lds
    s_add_u32 m0, s101, 19264
    s_nop 0
    buffer_load_dwordx4 v12, s[4:7], s80 offen offset:192 nt lds
    s_add_u32 m0, s101, 20224
    s_nop 0
    buffer_load_dwordx4 v12, s[4:7], s80 offen offset:256 nt lds
    s_add_u32 m0, s101, 21184
    s_nop 0
    buffer_load_dwordx4 v12, s[4:7], s80 offen offset:320 nt lds
    s_add_u32 m0, s101, 22144
    s_nop 0
    buffer_load_dwordx4 v12, s[4:7], s80 offen offset:384 nt lds
    s_add_u32 m0, s101, 23104
    s_nop 0
    buffer_load_dwordx4 v12, s[4:7], s80 offen offset:448 nt lds
    s_waitcnt vmcnt(8)
    s_add_u32 m0, s101, 24576
    s_nop 0
    buffer_load_dwordx4 v13, s[8:11], s80 offen offset:0 nt lds
    s_add_u32 m0, s101, 25344
    s_nop 0
    buffer_load_dwordx4 v13, s[8:11], s80 offen offset:256 nt lds
    s_add_u32 m0, s101, 26112
    s_nop 0
    buffer_load_dwordx4 v13, s[8:11], s80 offen offset:512 nt lds
    s_add_u32 m0, s101, 26880
    s_nop 0
    buffer_load_dwordx4 v13, s[8:11], s80 offen offset:768 nt lds
    s_add_u32 m0, s101, 27648
    s_nop 0
    buffer_load_dwordx4 v13, s[8:11], s80 offen offset:1024 nt lds
    s_add_u32 m0, s101, 28416
    s_nop 0
    buffer_load_dwordx4 v13, s[8:11], s80 offen offset:1280 nt lds
    s_add_u32 m0, s101, 29184
    s_nop 0
    buffer_load_dwordx4 v13, s[8:11], s80 offen offset:1536 nt lds
    s_add_u32 m0, s101, 29952
    s_nop 0
    buffer_load_dwordx4 v13, s[8:11], s80 offen offset:1792 nt lds
    s_add_u32 s80, s80, 524288
    s_waitcnt vmcnt(8)
    s_add_u32 m0, s101, 32768
    s_nop 0
    buffer_load_dwordx4 v12, s[4:7], s80 offen offset:0 nt lds
    s_add_u32 m0, s101, 33728
    s_nop 0
    buffer_load_dwordx4 v12, s[4:7], s80 offen offset:64 nt lds
    s_add_u32 m0, s101, 34688
    s_nop 0
    buffer_load_dwordx4 v12, s[4:7], s80 offen offset:128 nt lds
    s_add_u32 m0, s101, 35648
    s_nop 0
    buffer_load_dwordx4 v12, s[4:7], s80 offen offset:192 nt lds
    s_add_u32 m0, s101, 36608
    s_nop 0
    buffer_load_dwordx4 v12, s[4:7], s80 offen offset:256 nt lds
    s_add_u32 m0, s101, 37568
    s_nop 0
    buffer_load_dwordx4 v12, s[4:7], s80 offen offset:320 nt lds
    s_add_u32 m0, s101, 38528
    s_nop 0
    buffer_load_dwordx4 v12, s[4:7], s80 offen offset:384 nt lds
    s_add_u32 m0, s101, 39488
    s_nop 0
    buffer_load_dwordx4 v12, s[4:7], s80 offen offset:448 nt lds
    s_waitcnt vmcnt(8)
    s_add_u32 m0, s101, 40960
    s_nop 0
    buffer_load_dwordx4 v13, s[8:11], s80 offen offset:0 nt lds
    s_add_u32 m0, s101, 41728
    s_nop 0
    buffer_load_dwordx4 v13, s[8:11], s80 offen offset:256 nt lds
    s_add_u32 m0, s101, 42496
    s_nop 0
    buffer_load_dwordx4 v13, s[8:11], s80 offen offset:512 nt lds
    s_add_u32 m0, s101, 43264
    s_nop 0
    buffer_load_dwordx4 v13, s[8:11], s80 offen offset:768 nt lds
    s_add_u32 m0, s101, 44032
    s_nop 0
    buffer_load_dwordx4 v13, s[8:11], s80 offen offset:1024 nt lds
    s_add_u32 m0, s101, 44800
    s_nop 0
    buffer_load_dwordx4 v13, s[8:11], s80 offen offset:1280 nt lds
    s_add_u32 m0, s101, 45568
    s_nop 0
    buffer_load_dwordx4 v13, s[8:11], s80 offen offset:1536 nt lds
    s_add_u32 m0, s101, 46336
    s_nop 0
    buffer_load_dwordx4 v13, s[8:11], s80 offen offset:1792 nt lds
    s_add_u32 s80, s80, 524288
    s_waitcnt vmcnt(8)
    s_add_u32 m0, s101, 49152
    s_nop 0
    buffer_load_dwordx4 v12, s[4:7], s80 offen offset:0 nt lds
    s_add_u32 m0, s101, 50112
    s_nop 0
    buffer_load_dwordx4 v12, s[4:7], s80 offen offset:64 nt lds
    s_add_u32 m0, s101, 51072
    s_nop 0
    buffer_load_dwordx4 v12, s[4:7], s80 offen offset:128 nt lds
    s_add_u32 m0, s101, 52032
    s_nop 0
    buffer_load_dwordx4 v12, s[4:7], s80 offen offset:192 nt lds
    s_add_u32 m0, s101, 52992
    s_nop 0
    buffer_load_dwordx4 v12, s[4:7], s80 offen offset:256 nt lds
    s_add_u32 m0, s101, 53952
    s_nop 0
    buffer_load_dwordx4 v12, s[4:7], s80 offen offset:320 nt lds
    s_add_u32 m0, s101, 54912
    s_nop 0
    buffer_load_dwordx4 v12, s[4:7], s80 offen offset:384 nt lds
    s_add_u32 m0, s101, 55872
    s_nop 0
    buffer_load_dwordx4 v12, s[4:7], s80 offen offset:448 nt lds
    s_waitcnt vmcnt(8)
    s_add_u32 m0, s101, 57344
    s_nop 0
    buffer_load_dwordx4 v13, s[8:11], s80 offen offset:0 nt lds
    s_add_u32 m0, s101, 58112
    s_nop 0
    buffer_load_dwordx4 v13, s[8:11], s80 offen offset:256 nt lds
    s_add_u32 m0, s101, 58880
    s_nop 0
    buffer_load_dwordx4 v13, s[8:11], s80 offen offset:512 nt lds
    s_add_u32 m0, s101, 59648
    s_nop 0
    buffer_load_dwordx4 v13, s[8:11], s80 offen offset:768 nt lds
    s_add_u32 m0, s101, 60416
    s_nop 0
    buffer_load_dwordx4 v13, s[8:11], s80 offen offset:1024 nt lds
    s_add_u32 m0, s101, 61184
    s_nop 0
    buffer_load_dwordx4 v13, s[8:11], s80 offen offset:1280 nt lds
    s_add_u32 m0, s101, 61952
    s_nop 0
    buffer_load_dwordx4 v13, s[8:11], s80 offen offset:1536 nt lds
    s_add_u32 m0, s101, 62720
    s_nop 0
    buffer_load_dwordx4 v13, s[8:11], s80 offen offset:1792 nt lds
    s_add_u32 s80, s80, 524288
    v_mov_b32 v20, 0
    v_mov_b32 v21, 0
    v_mov_b32 v22, 0
    v_mov_b32 v23, 0
    v_mov_b32 v24, 0
    v_mov_b32 v25, 0
    v_mov_b32 v26, 0
    v_mov_b32 v27, 0
    v_mov_b32 v14, 0xf149f2ca
    v_mov_b32 v15, 0
    v_mov_b32 v3, 0
    v_and_b32 v4, 1, v1
    v_lshlrev_b32 v4, 9, v4
    v_lshrrev_b32 v5, 4, v1
    v_lshl_add_u32 v4, v5, 4, v4
    s_barrier
    ds_read_b128 v[32:35], v4 offset:0
    ds_read_b128 v[36:39], v4 offset:64
    ds_read_b128 v[40:43], v4 offset:128
    ds_read_b128 v[44:47], v4 offset:192
    ds_read_b128 v[48:51], v4 offset:256
    ds_read_b128 v[52:55], v4 offset:320
    ds_read_b128 v[56:59], v4 offset:384
    ds_read_b128 v[60:63], v4 offset:448
    s_waitcnt lgkmcnt(0)
    v_mfma_f32_16x16x32_bf16 v[16:19], v[64:67], v[32:35], 0
    v_mfma_f32_16x16x32_bf16 v[16:19], v[68:71], v[36:39], v[16:19]
    v_mfma_f32_16x16x32_bf16 v[16:19], v[72:75], v[40:43], v[16:19]
    v_mfma_f32_16x16x32_bf16 v[16:19], v[76:79], v[44:47], v[16:19]
    v_mfma_f32_16x16x32_bf16 v[16:19], v[80:83], v[48:51], v[16:19]
    v_mfma_f32_16x16x32_bf16 v[16:19], v[84:87], v[52:55], v[16:19]
    v_mfma_f32_16x16x32_bf16 v[16:19], v[88:91], v[56:59], v[16:19]
    v_mfma_f32_16x16x32_bf16 v[16:19], v[92:95], v[60:63], v[16:19]
    buffer_load_dwordx4 v[64:67], v12, s[4:7], s80 offen offset:0 nt
    buffer_load_dwordx4 v[68:71], v12, s[4:7], s80 offen offset:64 nt
    buffer_load_dwordx4 v[72:75], v12, s[4:7], s80 offen offset:128 nt
    buffer_load_dwordx4 v[76:79], v12, s[4:7], s80 offen offset:192 nt
    buffer_load_dwordx4 v[80:83], v12, s[4:7], s80 offen offset:256 nt
    buffer_load_dwordx4 v[84:87], v12, s[4:7], s80 offen offset:320 nt
    buffer_load_dwordx4 v[88:91], v12, s[4:7], s80 offen offset:384 nt
    buffer_load_dwordx4 v[92:95], v12, s[4:7], s80 offen offset:448 nt
    v_cvt_pk_bf16_f32 v0, v16, v17
    v_cvt_pk_bf16_f32 v4, v18, v19
    v_lshlrev_b32 v16, 16, v0
    v_and_b32 v17, 0xffff0000, v0
    v_lshlrev_b32 v18, 16, v4
    v_and_b32 v19, 0xffff0000, v4
    v_max3_f32 v0, v16, v17, v18
    v_max_f32 v0, v0, v19
    v_mov_b32 v4, v0
    s_nop 1
    v_permlane16_swap_b32 v0, v4
    v_max_f32 v0, v0, v4
    v_mov_b32 v4, v0
    s_nop 1
    v_permlane32_swap_b32 v0, v4
    v_max_f32 v0, v0, v4
    v_mul_f32 v0, s64, v0
    v_ceil_f32 v0, v0
    v_max_f32 v0, v0, v14
    v_sub_f32 v4, v14, v0
    v_exp_f32 v4, v4
    v_mov_b32 v14, v0
    v_fma_f32 v16, v16, s64, -v0
    v_fma_f32 v17, v17, s64, -v0
    v_fma_f32 v18, v18, s64, -v0
    v_fma_f32 v19, v19, s64, -v0
    v_exp_f32 v16, v16
    v_exp_f32 v17, v17
    v_exp_f32 v18, v18
    v_exp_f32 v19, v19
    v_mul_f32_dpp v20, v4, v20 quad_perm:[0,0,2,2] row_mask:0xf bank_mask:0xf
    v_mul_f32_dpp v21, v4, v21 quad_perm:[1,1,3,3] row_mask:0xf bank_mask:0xf
    v_mul_f32_dpp v22, v4, v22 quad_perm:[0,0,2,2] row_mask:0xf bank_mask:0xf
    v_mul_f32_dpp v23, v4, v23 quad_perm:[1,1,3,3] row_mask:0xf bank_mask:0xf
    v_mul_f32_dpp v24, v4, v24 quad_perm:[0,0,2,2] row_mask:0xf bank_mask:0xf
    v_mul_f32_dpp v25, v4, v25 quad_perm:[1,1,3,3] row_mask:0xf bank_mask:0xf
    v_mul_f32_dpp v26, v4, v26 quad_perm:[0,0,2,2] row_mask:0xf bank_mask:0xf
    v_mul_f32_dpp v27, v4, v27 quad_perm:[1,1,3,3] row_mask:0xf bank_mask:0xf
    v_add_f32 v6, v16, v17
    v_add_f32 v7, v18, v19
    v_add_f32 v6, v6, v7
    v_fma_f32 v15, v15, v4, v6
    v_cvt_pk_bf16_f32 v16, v16, v16
    v_cvt_pk_bf16_f32 v17, v17, v17
    v_cvt_pk_bf16_f32 v18, v18, v18
    v_cvt_pk_bf16_f32 v19, v19, v19
    v_and_b32 v28, v16, v8
    v_and_b32 v29, v16, v9
    v_and_b32 v30, v16, v10
    v_and_b32 v31, v16, v11
    s_nop 1
    v_mfma_f32_16x16x32_bf16 v[20:23], v[28:31], v[96:99], v[20:23]
    v_mfma_f32_16x16x32_bf16 v[24:27], v[28:31], v[100:103], v[24:27]
    v_and_b32 v28, v17, v8
    v_and_b32 v29, v17, v9
    v_and_b32 v30, v17, v10
    v_and_b32 v31, v17, v11
    s_nop 1
    v_mfma_f32_16x16x32_bf16 v[20:23], v[28:31], v[104:107], v[20:23]
    v_mfma_f32_16x16x32_bf16 v[24:27], v[28:31], v[108:111], v[24:27]
    v_and_b32 v28, v18, v8
    v_and_b32 v29, v18, v9
    v_and_b32 v30, v18, v10
    v_and_b32 v31, v18, v11
    s_nop 1
    v_mfma_f32_16x16x32_bf16 v[20:23], v[28:31], v[112:115], v[20:23]
    v_mfma_f32_16x16x32_bf16 v[24:27], v[28:31], v[116:119], v[24:27]
    v_and_b32 v28, v19, v8
    v_and_b32 v29, v19, v9
    v_and_b32 v30, v19, v10
    v_and_b32 v31, v19, v11
    s_nop 1
    v_mfma_f32_16x16x32_bf16 v[20:23], v[28:31], v[120:123], v[20:23]
    v_mfma_f32_16x16x32_bf16 v[24:27], v[28:31], v[124:127], v[24:27]
    buffer_load_dwordx4 v[96:99], v13, s[8:11], s80 offen offset:0 nt
    buffer_load_dwordx4 v[100:103], v13, s[8:11], s80 offen offset:256 nt
    buffer_load_dwordx4 v[104:107], v13, s[8:11], s80 offen offset:512 nt
    buffer_load_dwordx4 v[108:111], v13, s[8:11], s80 offen offset:768 nt
    buffer_load_dwordx4 v[112:115], v13, s[8:11], s80 offen offset:1024 nt
    buffer_load_dwordx4 v[116:119], v13, s[8:11], s80 offen offset:1280 nt
    buffer_load_dwordx4 v[120:123], v13, s[8:11], s80 offen offset:1536 nt
    buffer_load_dwordx4 v[124:127], v13, s[8:11], s80 offen offset:1792 nt
    s_add_u32 s80, s80, 524288
    v_mfma_f32_16x16x32_bf16 v[16:19], v[128:131], v[32:35], 0
    v_mfma_f32_16x16x32_bf16 v[16:19], v[132:135], v[36:39], v[16:19]
    v_mfma_f32_16x16x32_bf16 v[16:19], v[136:139], v[40:43], v[16:19]
    v_mfma_f32_16x16x32_bf16 v[16:19], v[140:143], v[44:47], v[16:19]
    v_mfma_f32_16x16x32_bf16 v[16:19], v[144:147], v[48:51], v[16:19]
    v_mfma_f32_16x16x32_bf16 v[16:19], v[148:151], v[52:55], v[16:19]
    v_mfma_f32_16x16x32_bf16 v[16:19], v[152:155], v[56:59], v[16:19]
    v_mfma_f32_16x16x32_bf16 v[16:19], v[156:159], v[60:63], v[16:19]
    s_nop 7
    v_cvt_pk_bf16_f32 v0, v16, v17
    v_cvt_pk_bf16_f32 v4, v18, v19
    v_lshlrev_b32 v16, 16, v0
    v_and_b32 v17, 0xffff0000, v0
    v_lshlrev_b32 v18, 16, v4
    v_and_b32 v19, 0xffff0000, v4
    v_max3_f32 v0, v16, v17, v18
    v_max_f32 v0, v0, v19
    v_mov_b32 v4, v0
    s_nop 1
    v_permlane16_swap_b32 v0, v4
    v_max_f32 v0, v0, v4
    v_mov_b32 v4, v0
    s_nop 1
    v_permlane32_swap_b32 v0, v4
    v_max_f32 v0, v0, v4
    v_mul_f32 v0, s64, v0
    v_ceil_f32 v0, v0
    v_max_f32 v0, v0, v14
    v_sub_f32 v4, v14, v0
    v_exp_f32 v4, v4
    v_mov_b32 v14, v0
    v_fma_f32 v16, v16, s64, -v0
    v_fma_f32 v17, v17, s64, -v0
    v_fma_f32 v18, v18, s64, -v0
    v_fma_f32 v19, v19, s64, -v0
    v_exp_f32 v16, v16
    v_exp_f32 v17, v17
    v_exp_f32 v18, v18
    v_exp_f32 v19, v19
    v_mul_f32_dpp v20, v4, v20 quad_perm:[0,0,2,2] row_mask:0xf bank_mask:0xf
    v_mul_f32_dpp v21, v4, v21 quad_perm:[1,1,3,3] row_mask:0xf bank_mask:0xf
    v_mul_f32_dpp v22, v4, v22 quad_perm:[0,0,2,2] row_mask:0xf bank_mask:0xf
    v_mul_f32_dpp v23, v4, v23 quad_perm:[1,1,3,3] row_mask:0xf bank_mask:0xf
    v_mul_f32_dpp v24, v4, v24 quad_perm:[0,0,2,2] row_mask:0xf bank_mask:0xf
    v_mul_f32_dpp v25, v4, v25 quad_perm:[1,1,3,3] row_mask:0xf bank_mask:0xf
    v_mul_f32_dpp v26, v4, v26 quad_perm:[0,0,2,2] row_mask:0xf bank_mask:0xf
    v_mul_f32_dpp v27, v4, v27 quad_perm:[1,1,3,3] row_mask:0xf bank_mask:0xf
    v_add_f32 v6, v16, v17
    v_add_f32 v7, v18, v19
    v_add_f32 v6, v6, v7
    v_fma_f32 v15, v15, v4, v6
    v_cvt_pk_bf16_f32 v16, v16, v16
    v_cvt_pk_bf16_f32 v17, v17, v17
    v_cvt_pk_bf16_f32 v18, v18, v18
    v_cvt_pk_bf16_f32 v19, v19, v19
    v_and_b32 v28, v16, v8
    v_and_b32 v29, v16, v9
    v_and_b32 v30, v16, v10
    v_and_b32 v31, v16, v11
    s_nop 1
    v_mfma_f32_16x16x32_bf16 v[20:23], v[28:31], v[160:163], v[20:23]
    v_mfma_f32_16x16x32_bf16 v[24:27], v[28:31], v[164:167], v[24:27]
    v_and_b32 v28, v17, v8
    v_and_b32 v29, v17, v9
    v_and_b32 v30, v17, v10
    v_and_b32 v31, v17, v11
    s_nop 1
    v_mfma_f32_16x16x32_bf16 v[20:23], v[28:31], v[168:171], v[20:23]
    v_mfma_f32_16x16x32_bf16 v[24:27], v[28:31], v[172:175], v[24:27]
    v_and_b32 v28, v18, v8
    v_and_b32 v29, v18, v9
    v_and_b32 v30, v18, v10
    v_and_b32 v31, v18, v11
    s_nop 1
    v_mfma_f32_16x16x32_bf16 v[20:23], v[28:31], v[176:179], v[20:23]
    v_mfma_f32_16x16x32_bf16 v[24:27], v[28:31], v[180:183], v[24:27]
    v_and_b32 v28, v19, v8
    v_and_b32 v29, v19, v9
    v_and_b32 v30, v19, v10
    v_and_b32 v31, v19, v11
    s_nop 1
    v_mfma_f32_16x16x32_bf16 v[20:23], v[28:31], v[184:187], v[20:23]
    v_mfma_f32_16x16x32_bf16 v[24:27], v[28:31], v[188:191], v[24:27]
    ds_read_b128 v[128:131], v2 offset:0
    ds_read_b128 v[132:135], v2 offset:1024
    ds_read_b128 v[136:139], v2 offset:2048
    ds_read_b128 v[140:143], v2 offset:3072
    ds_read_b128 v[144:147], v2 offset:4096
    ds_read_b128 v[148:151], v2 offset:5120
    ds_read_b128 v[152:155], v2 offset:6144
    ds_read_b128 v[156:159], v2 offset:7168
    ds_read_b128 v[160:163], v2 offset:8192
    ds_read_b128 v[164:167], v2 offset:9216
    ds_read_b128 v[168:171], v2 offset:10240
    ds_read_b128 v[172:175], v2 offset:11264
    ds_read_b128 v[176:179], v2 offset:12288
    ds_read_b128 v[180:183], v2 offset:13312
    ds_read_b128 v[184:187], v2 offset:14336
    ds_read_b128 v[188:191], v2 offset:15360
    v_mfma_f32_16x16x32_bf16 v[16:19], v[192:195], v[32:35], 0
    v_mfma_f32_16x16x32_bf16 v[16:19], v[196:199], v[36:39], v[16:19]
    v_mfma_f32_16x16x32_bf16 v[16:19], v[200:203], v[40:43], v[16:19]
    v_mfma_f32_16x16x32_bf16 v[16:19], v[204:207], v[44:47], v[16:19]
    v_mfma_f32_16x16x32_bf16 v[16:19], v[208:211], v[48:51], v[16:19]
    v_mfma_f32_16x16x32_bf16 v[16:19], v[212:215], v[52:55], v[16:19]
    v_mfma_f32_16x16x32_bf16 v[16:19], v[216:219], v[56:59], v[16:19]
    v_mfma_f32_16x16x32_bf16 v[16:19], v[220:223], v[60:63], v[16:19]
    s_nop 7
    v_cvt_pk_bf16_f32 v0, v16, v17
    v_cvt_pk_bf16_f32 v4, v18, v19
    v_lshlrev_b32 v16, 16, v0
    v_and_b32 v17, 0xffff0000, v0
    v_lshlrev_b32 v18, 16, v4
    v_and_b32 v19, 0xffff0000, v4
    v_max3_f32 v0, v16, v17, v18
    v_max_f32 v0, v0, v19
    v_mov_b32 v4, v0
    s_nop 1
    v_permlane16_swap_b32 v0, v4
    v_max_f32 v0, v0, v4
    v_mov_b32 v4, v0
    s_nop 1
    v_permlane32_swap_b32 v0, v4
    v_max_f32 v0, v0, v4
    v_mul_f32 v0, s64, v0
    v_ceil_f32 v0, v0
    v_max_f32 v0, v0, v14
    v_sub_f32 v4, v14, v0
    v_exp_f32 v4, v4
    v_mov_b32 v14, v0
    v_fma_f32 v16, v16, s64, -v0
    v_fma_f32 v17, v17, s64, -v0
    v_fma_f32 v18, v18, s64, -v0
    v_fma_f32 v19, v19, s64, -v0
    v_exp_f32 v16, v16
    v_exp_f32 v17, v17
    v_exp_f32 v18, v18
    v_exp_f32 v19, v19
    v_mul_f32_dpp v20, v4, v20 quad_perm:[0,0,2,2] row_mask:0xf bank_mask:0xf
    v_mul_f32_dpp v21, v4, v21 quad_perm:[1,1,3,3] row_mask:0xf bank_mask:0xf
    v_mul_f32_dpp v22, v4, v22 quad_perm:[0,0,2,2] row_mask:0xf bank_mask:0xf
    v_mul_f32_dpp v23, v4, v23 quad_perm:[1,1,3,3] row_mask:0xf bank_mask:0xf
    v_mul_f32_dpp v24, v4, v24 quad_perm:[0,0,2,2] row_mask:0xf bank_mask:0xf
    v_mul_f32_dpp v25, v4, v25 quad_perm:[1,1,3,3] row_mask:0xf bank_mask:0xf
    v_mul_f32_dpp v26, v4, v26 quad_perm:[0,0,2,2] row_mask:0xf bank_mask:0xf
    v_mul_f32_dpp v27, v4, v27 quad_perm:[1,1,3,3] row_mask:0xf bank_mask:0xf
    v_add_f32 v6, v16, v17
    v_add_f32 v7, v18, v19
    v_add_f32 v6, v6, v7
    v_fma_f32 v15, v15, v4, v6
    v_cvt_pk_bf16_f32 v16, v16, v16
    v_cvt_pk_bf16_f32 v17, v17, v17
    v_cvt_pk_bf16_f32 v18, v18, v18
    v_cvt_pk_bf16_f32 v19, v19, v19
    v_and_b32 v28, v16, v8
    v_and_b32 v29, v16, v9
    v_and_b32 v30, v16, v10
    v_and_b32 v31, v16, v11
    s_nop 1
    v_mfma_f32_16x16x32_bf16 v[20:23], v[28:31], v[224:227], v[20:23]
    v_mfma_f32_16x16x32_bf16 v[24:27], v[28:31], v[228:231], v[24:27]
    v_and_b32 v28, v17, v8
    v_and_b32 v29, v17, v9
    v_and_b32 v30, v17, v10
    v_and_b32 v31, v17, v11
    s_nop 1
    v_mfma_f32_16x16x32_bf16 v[20:23], v[28:31], v[232:235], v[20:23]
    v_mfma_f32_16x16x32_bf16 v[24:27], v[28:31], v[236:239], v[24:27]
    v_and_b32 v28, v18, v8
    v_and_b32 v29, v18, v9
    v_and_b32 v30, v18, v10
    v_and_b32 v31, v18, v11
    s_nop 1
    v_mfma_f32_16x16x32_bf16 v[20:23], v[28:31], v[240:243], v[20:23]
    v_mfma_f32_16x16x32_bf16 v[24:27], v[28:31], v[244:247], v[24:27]
    v_and_b32 v28, v19, v8
    v_and_b32 v29, v19, v9
    v_and_b32 v30, v19, v10
    v_and_b32 v31, v19, v11
    s_nop 1
    v_mfma_f32_16x16x32_bf16 v[20:23], v[28:31], v[248:251], v[20:23]
    v_mfma_f32_16x16x32_bf16 v[24:27], v[28:31], v[252:255], v[24:27]
    ds_read_b128 v[192:195], v2 offset:16384
    ds_read_b128 v[196:199], v2 offset:17408
    ds_read_b128 v[200:203], v2 offset:18432
    ds_read_b128 v[204:207], v2 offset:19456
    ds_read_b128 v[208:211], v2 offset:20480
    ds_read_b128 v[212:215], v2 offset:21504
    ds_read_b128 v[216:219], v2 offset:22528
    ds_read_b128 v[220:223], v2 offset:23552
    ds_read_b128 v[224:227], v2 offset:24576
    ds_read_b128 v[228:231], v2 offset:25600
    ds_read_b128 v[232:235], v2 offset:26624
    ds_read_b128 v[236:239], v2 offset:27648
    ds_read_b128 v[240:243], v2 offset:28672
    ds_read_b128 v[244:247], v2 offset:29696
    ds_read_b128 v[248:251], v2 offset:30720
    ds_read_b128 v[252:255], v2 offset:31744
    s_waitcnt vmcnt(8)
    v_mfma_f32_16x16x32_bf16 v[16:19], v[64:67], v[32:35], 0
    v_mfma_f32_16x16x32_bf16 v[16:19], v[68:71], v[36:39], v[16:19]
    v_mfma_f32_16x16x32_bf16 v[16:19], v[72:75], v[40:43], v[16:19]
    v_mfma_f32_16x16x32_bf16 v[16:19], v[76:79], v[44:47], v[16:19]
    v_mfma_f32_16x16x32_bf16 v[16:19], v[80:83], v[48:51], v[16:19]
    v_mfma_f32_16x16x32_bf16 v[16:19], v[84:87], v[52:55], v[16:19]
    v_mfma_f32_16x16x32_bf16 v[16:19], v[88:91], v[56:59], v[16:19]
    v_mfma_f32_16x16x32_bf16 v[16:19], v[92:95], v[60:63], v[16:19]
    buffer_load_dwordx4 v[64:67], v12, s[4:7], s80 offen offset:0 nt
    buffer_load_dwordx4 v[68:71], v12, s[4:7], s80 offen offset:64 nt
    buffer_load_dwordx4 v[72:75], v12, s[4:7], s80 offen offset:128 nt
    buffer_load_dwordx4 v[76:79], v12, s[4:7], s80 offen offset:192 nt
    buffer_load_dwordx4 v[80:83], v12, s[4:7], s80 offen offset:256 nt
    buffer_load_dwordx4 v[84:87], v12, s[4:7], s80 offen offset:320 nt
    buffer_load_dwordx4 v[88:91], v12, s[4:7], s80 offen offset:384 nt
    buffer_load_dwordx4 v[92:95], v12, s[4:7], s80 offen offset:448 nt
    v_cvt_pk_bf16_f32 v0, v16, v17
    v_cvt_pk_bf16_f32 v4, v18, v19
    v_lshlrev_b32 v16, 16, v0
    v_and_b32 v17, 0xffff0000, v0
    v_lshlrev_b32 v18, 16, v4
    v_and_b32 v19, 0xffff0000, v4
    v_max3_f32 v0, v16, v17, v18
    v_max_f32 v0, v0, v19
    v_mov_b32 v4, v0
    s_nop 1
    v_permlane16_swap_b32 v0, v4
    v_max_f32 v0, v0, v4
    v_mov_b32 v4, v0
    s_nop 1
    v_permlane32_swap_b32 v0, v4
    v_max_f32 v0, v0, v4
    v_mul_f32 v0, s64, v0
    v_ceil_f32 v0, v0
    v_max_f32 v0, v0, v14
    v_sub_f32 v4, v14, v0
    v_exp_f32 v4, v4
    v_mov_b32 v14, v0
    v_fma_f32 v16, v16, s64, -v0
    v_fma_f32 v17, v17, s64, -v0
    v_fma_f32 v18, v18, s64, -v0
    v_fma_f32 v19, v19, s64, -v0
    v_exp_f32 v16, v16
    v_exp_f32 v17, v17
    v_exp_f32 v18, v18
    v_exp_f32 v19, v19
    v_mul_f32_dpp v20, v4, v20 quad_perm:[0,0,2,2] row_mask:0xf bank_mask:0xf
    v_mul_f32_dpp v21, v4, v21 quad_perm:[1,1,3,3] row_mask:0xf bank_mask:0xf
    v_mul_f32_dpp v22, v4, v22 quad_perm:[0,0,2,2] row_mask:0xf bank_mask:0xf
    v_mul_f32_dpp v23, v4, v23 quad_perm:[1,1,3,3] row_mask:0xf bank_mask:0xf
    v_mul_f32_dpp v24, v4, v24 quad_perm:[0,0,2,2] row_mask:0xf bank_mask:0xf
    v_mul_f32_dpp v25, v4, v25 quad_perm:[1,1,3,3] row_mask:0xf bank_mask:0xf
    v_mul_f32_dpp v26, v4, v26 quad_perm:[0,0,2,2] row_mask:0xf bank_mask:0xf
    v_mul_f32_dpp v27, v4, v27 quad_perm:[1,1,3,3] row_mask:0xf bank_mask:0xf
    v_add_f32 v6, v16, v17
    v_add_f32 v7, v18, v19
    v_add_f32 v6, v6, v7
    v_fma_f32 v15, v15, v4, v6
    v_cvt_pk_bf16_f32 v16, v16, v16
    v_cvt_pk_bf16_f32 v17, v17, v17
    v_cvt_pk_bf16_f32 v18, v18, v18
    v_cvt_pk_bf16_f32 v19, v19, v19
    s_waitcnt vmcnt(8)
    v_and_b32 v28, v16, v8
    v_and_b32 v29, v16, v9
    v_and_b32 v30, v16, v10
    v_and_b32 v31, v16, v11
    s_nop 1
    v_mfma_f32_16x16x32_bf16 v[20:23], v[28:31], v[96:99], v[20:23]
    v_mfma_f32_16x16x32_bf16 v[24:27], v[28:31], v[100:103], v[24:27]
    v_and_b32 v28, v17, v8
    v_and_b32 v29, v17, v9
    v_and_b32 v30, v17, v10
    v_and_b32 v31, v17, v11
    s_nop 1
    v_mfma_f32_16x16x32_bf16 v[20:23], v[28:31], v[104:107], v[20:23]
    v_mfma_f32_16x16x32_bf16 v[24:27], v[28:31], v[108:111], v[24:27]
    v_and_b32 v28, v18, v8
    v_and_b32 v29, v18, v9
    v_and_b32 v30, v18, v10
    v_and_b32 v31, v18, v11
    s_nop 1
    v_mfma_f32_16x16x32_bf16 v[20:23], v[28:31], v[112:115], v[20:23]
    v_mfma_f32_16x16x32_bf16 v[24:27], v[28:31], v[116:119], v[24:27]
    v_and_b32 v28, v19, v8
    v_and_b32 v29, v19, v9
    v_and_b32 v30, v19, v10
    v_and_b32 v31, v19, v11
    s_nop 1
    v_mfma_f32_16x16x32_bf16 v[20:23], v[28:31], v[120:123], v[20:23]
    v_mfma_f32_16x16x32_bf16 v[24:27], v[28:31], v[124:127], v[24:27]
    buffer_load_dwordx4 v[96:99], v13, s[8:11], s80 offen offset:0 nt
    buffer_load_dwordx4 v[100:103], v13, s[8:11], s80 offen offset:256 nt
    buffer_load_dwordx4 v[104:107], v13, s[8:11], s80 offen offset:512 nt
    buffer_load_dwordx4 v[108:111], v13, s[8:11], s80 offen offset:768 nt
    buffer_load_dwordx4 v[112:115], v13, s[8:11], s80 offen offset:1024 nt
    buffer_load_dwordx4 v[116:119], v13, s[8:11], s80 offen offset:1280 nt
    buffer_load_dwordx4 v[120:123], v13, s[8:11], s80 offen offset:1536 nt
    buffer_load_dwordx4 v[124:127], v13, s[8:11], s80 offen offset:1792 nt
    s_add_u32 s80, s80, 524288
    v_mfma_f32_16x16x32_bf16 v[16:19], a[0:3], v[32:35], 0
    v_mfma_f32_16x16x32_bf16 v[16:19], a[4:7], v[36:39], v[16:19]
    v_mfma_f32_16x16x32_bf16 v[16:19], a[8:11], v[40:43], v[16:19]
    v_mfma_f32_16x16x32_bf16 v[16:19], a[12:15], v[44:47], v[16:19]
    v_mfma_f32_16x16x32_bf16 v[16:19], a[16:19], v[48:51], v[16:19]
    v_mfma_f32_16x16x32_bf16 v[16:19], a[20:23], v[52:55], v[16:19]
    v_mfma_f32_16x16x32_bf16 v[16:19], a[24:27], v[56:59], v[16:19]
    v_mfma_f32_16x16x32_bf16 v[16:19], a[28:31], v[60:63], v[16:19]
    s_nop 7
    v_cvt_pk_bf16_f32 v0, v16, v17
    v_cvt_pk_bf16_f32 v4, v18, v19
    v_lshlrev_b32 v16, 16, v0
    v_and_b32 v17, 0xffff0000, v0
    v_lshlrev_b32 v18, 16, v4
    v_and_b32 v19, 0xffff0000, v4
    v_max3_f32 v0, v16, v17, v18
    v_max_f32 v0, v0, v19
    v_mov_b32 v4, v0
    s_nop 1
    v_permlane16_swap_b32 v0, v4
    v_max_f32 v0, v0, v4
    v_mov_b32 v4, v0
    s_nop 1
    v_permlane32_swap_b32 v0, v4
    v_max_f32 v0, v0, v4
    v_mul_f32 v0, s64, v0
    v_ceil_f32 v0, v0
    v_max_f32 v0, v0, v14
    v_sub_f32 v4, v14, v0
    v_exp_f32 v4, v4
    v_mov_b32 v14, v0
    v_fma_f32 v16, v16, s64, -v0
    v_fma_f32 v17, v17, s64, -v0
    v_fma_f32 v18, v18, s64, -v0
    v_fma_f32 v19, v19, s64, -v0
    v_exp_f32 v16, v16
    v_exp_f32 v17, v17
    v_exp_f32 v18, v18
    v_exp_f32 v19, v19
    v_mul_f32_dpp v20, v4, v20 quad_perm:[0,0,2,2] row_mask:0xf bank_mask:0xf
    v_mul_f32_dpp v21, v4, v21 quad_perm:[1,1,3,3] row_mask:0xf bank_mask:0xf
    v_mul_f32_dpp v22, v4, v22 quad_perm:[0,0,2,2] row_mask:0xf bank_mask:0xf
    v_mul_f32_dpp v23, v4, v23 quad_perm:[1,1,3,3] row_mask:0xf bank_mask:0xf
    v_mul_f32_dpp v24, v4, v24 quad_perm:[0,0,2,2] row_mask:0xf bank_mask:0xf
    v_mul_f32_dpp v25, v4, v25 quad_perm:[1,1,3,3] row_mask:0xf bank_mask:0xf
    v_mul_f32_dpp v26, v4, v26 quad_perm:[0,0,2,2] row_mask:0xf bank_mask:0xf
    v_mul_f32_dpp v27, v4, v27 quad_perm:[1,1,3,3] row_mask:0xf bank_mask:0xf
    v_add_f32 v6, v16, v17
    v_add_f32 v7, v18, v19
    v_add_f32 v6, v6, v7
    v_fma_f32 v15, v15, v4, v6
    v_cvt_pk_bf16_f32 v16, v16, v16
    v_cvt_pk_bf16_f32 v17, v17, v17
    v_cvt_pk_bf16_f32 v18, v18, v18
    v_cvt_pk_bf16_f32 v19, v19, v19
    v_and_b32 v28, v16, v8
    v_and_b32 v29, v16, v9
    v_and_b32 v30, v16, v10
    v_and_b32 v31, v16, v11
    s_nop 1
    v_mfma_f32_16x16x32_bf16 v[20:23], v[28:31], a[32:35], v[20:23]
    v_mfma_f32_16x16x32_bf16 v[24:27], v[28:31], a[36:39], v[24:27]
    v_and_b32 v28, v17, v8
    v_and_b32 v29, v17, v9
    v_and_b32 v30, v17, v10
    v_and_b32 v31, v17, v11
    s_nop 1
    v_mfma_f32_16x16x32_bf16 v[20:23], v[28:31], a[40:43], v[20:23]
    v_mfma_f32_16x16x32_bf16 v[24:27], v[28:31], a[44:47], v[24:27]
    v_and_b32 v28, v18, v8
    v_and_b32 v29, v18, v9
    v_and_b32 v30, v18, v10
    v_and_b32 v31, v18, v11
    s_nop 1
    v_mfma_f32_16x16x32_bf16 v[20:23], v[28:31], a[48:51], v[20:23]
    v_mfma_f32_16x16x32_bf16 v[24:27], v[28:31], a[52:55], v[24:27]
    v_and_b32 v28, v19, v8
    v_and_b32 v29, v19, v9
    v_and_b32 v30, v19, v10
    v_and_b32 v31, v19, v11
    s_nop 1
    v_mfma_f32_16x16x32_bf16 v[20:23], v[28:31], a[56:59], v[20:23]
    v_mfma_f32_16x16x32_bf16 v[24:27], v[28:31], a[60:63], v[24:27]
    ds_read_b128 a[0:3], v2 offset:32768
    ds_read_b128 a[4:7], v2 offset:33792
    ds_read_b128 a[8:11], v2 offset:34816
    ds_read_b128 a[12:15], v2 offset:35840
    ds_read_b128 a[16:19], v2 offset:36864
    ds_read_b128 a[20:23], v2 offset:37888
    ds_read_b128 a[24:27], v2 offset:38912
    ds_read_b128 a[28:31], v2 offset:39936
    ds_read_b128 a[32:35], v2 offset:40960
    ds_read_b128 a[36:39], v2 offset:41984
    ds_read_b128 a[40:43], v2 offset:43008
    ds_read_b128 a[44:47], v2 offset:44032
    ds_read_b128 a[48:51], v2 offset:45056
    ds_read_b128 a[52:55], v2 offset:46080
    ds_read_b128 a[56:59], v2 offset:47104
    ds_read_b128 a[60:63], v2 offset:48128
    v_mfma_f32_16x16x32_bf16 v[16:19], a[64:67], v[32:35], 0
    v_mfma_f32_16x16x32_bf16 v[16:19], a[68:71], v[36:39], v[16:19]
    v_mfma_f32_16x16x32_bf16 v[16:19], a[72:75], v[40:43], v[16:19]
    v_mfma_f32_16x16x32_bf16 v[16:19], a[76:79], v[44:47], v[16:19]
    v_mfma_f32_16x16x32_bf16 v[16:19], a[80:83], v[48:51], v[16:19]
    v_mfma_f32_16x16x32_bf16 v[16:19], a[84:87], v[52:55], v[16:19]
    v_mfma_f32_16x16x32_bf16 v[16:19], a[88:91], v[56:59], v[16:19]
    v_mfma_f32_16x16x32_bf16 v[16:19], a[92:95], v[60:63], v[16:19]
    s_nop 7
    v_cvt_pk_bf16_f32 v0, v16, v17
    v_cvt_pk_bf16_f32 v4, v18, v19
    v_lshlrev_b32 v16, 16, v0
    v_and_b32 v17, 0xffff0000, v0
    v_lshlrev_b32 v18, 16, v4
    v_and_b32 v19, 0xffff0000, v4
    v_max3_f32 v0, v16, v17, v18
    v_max_f32 v0, v0, v19
    v_mov_b32 v4, v0
    s_nop 1
    v_permlane16_swap_b32 v0, v4
    v_max_f32 v0, v0, v4
    v_mov_b32 v4, v0
    s_nop 1
    v_permlane32_swap_b32 v0, v4
    v_max_f32 v0, v0, v4
    v_mul_f32 v0, s64, v0
    v_ceil_f32 v0, v0
    v_max_f32 v0, v0, v14
    v_sub_f32 v4, v14, v0
    v_exp_f32 v4, v4
    v_mov_b32 v14, v0
    v_fma_f32 v16, v16, s64, -v0
    v_fma_f32 v17, v17, s64, -v0
    v_fma_f32 v18, v18, s64, -v0
    v_fma_f32 v19, v19, s64, -v0
    v_exp_f32 v16, v16
    v_exp_f32 v17, v17
    v_exp_f32 v18, v18
    v_exp_f32 v19, v19
    v_mul_f32_dpp v20, v4, v20 quad_perm:[0,0,2,2] row_mask:0xf bank_mask:0xf
    v_mul_f32_dpp v21, v4, v21 quad_perm:[1,1,3,3] row_mask:0xf bank_mask:0xf
    v_mul_f32_dpp v22, v4, v22 quad_perm:[0,0,2,2] row_mask:0xf bank_mask:0xf
    v_mul_f32_dpp v23, v4, v23 quad_perm:[1,1,3,3] row_mask:0xf bank_mask:0xf
    v_mul_f32_dpp v24, v4, v24 quad_perm:[0,0,2,2] row_mask:0xf bank_mask:0xf
    v_mul_f32_dpp v25, v4, v25 quad_perm:[1,1,3,3] row_mask:0xf bank_mask:0xf
    v_mul_f32_dpp v26, v4, v26 quad_perm:[0,0,2,2] row_mask:0xf bank_mask:0xf
    v_mul_f32_dpp v27, v4, v27 quad_perm:[1,1,3,3] row_mask:0xf bank_mask:0xf
    v_add_f32 v6, v16, v17
    v_add_f32 v7, v18, v19
    v_add_f32 v6, v6, v7
    v_fma_f32 v15, v15, v4, v6
    v_cvt_pk_bf16_f32 v16, v16, v16
    v_cvt_pk_bf16_f32 v17, v17, v17
    v_cvt_pk_bf16_f32 v18, v18, v18
    v_cvt_pk_bf16_f32 v19, v19, v19
    v_and_b32 v28, v16, v8
    v_and_b32 v29, v16, v9
    v_and_b32 v30, v16, v10
    v_and_b32 v31, v16, v11
    s_nop 1
    v_mfma_f32_16x16x32_bf16 v[20:23], v[28:31], a[96:99], v[20:23]
    v_mfma_f32_16x16x32_bf16 v[24:27], v[28:31], a[100:103], v[24:27]
    v_and_b32 v28, v17, v8
    v_and_b32 v29, v17, v9
    v_and_b32 v30, v17, v10
    v_and_b32 v31, v17, v11
    s_nop 1
    v_mfma_f32_16x16x32_bf16 v[20:23], v[28:31], a[104:107], v[20:23]
    v_mfma_f32_16x16x32_bf16 v[24:27], v[28:31], a[108:111], v[24:27]
    v_and_b32 v28, v18, v8
    v_and_b32 v29, v18, v9
    v_and_b32 v30, v18, v10
    v_and_b32 v31, v18, v11
    s_nop 1
    v_mfma_f32_16x16x32_bf16 v[20:23], v[28:31], a[112:115], v[20:23]
    v_mfma_f32_16x16x32_bf16 v[24:27], v[28:31], a[116:119], v[24:27]
    v_and_b32 v28, v19, v8
    v_and_b32 v29, v19, v9
    v_and_b32 v30, v19, v10
    v_and_b32 v31, v19, v11
    s_nop 1
    v_mfma_f32_16x16x32_bf16 v[20:23], v[28:31], a[120:123], v[20:23]
    v_mfma_f32_16x16x32_bf16 v[24:27], v[28:31], a[124:127], v[24:27]
    ds_read_b128 a[64:67], v2 offset:49152
    ds_read_b128 a[68:71], v2 offset:50176
    ds_read_b128 a[72:75], v2 offset:51200
    ds_read_b128 a[76:79], v2 offset:52224
    ds_read_b128 a[80:83], v2 offset:53248
    ds_read_b128 a[84:87], v2 offset:54272
    ds_read_b128 a[88:91], v2 offset:55296
    ds_read_b128 a[92:95], v2 offset:56320
    ds_read_b128 a[96:99], v2 offset:57344
    ds_read_b128 a[100:103], v2 offset:58368
    ds_read_b128 a[104:107], v2 offset:59392
    ds_read_b128 a[108:111], v2 offset:60416
    ds_read_b128 a[112:115], v2 offset:61440
    ds_read_b128 a[116:119], v2 offset:62464
    ds_read_b128 a[120:123], v2 offset:63488
    ds_read_b128 a[124:127], v2 offset:64512
    s_waitcnt vmcnt(8)
    v_mfma_f32_16x16x32_bf16 v[16:19], v[64:67], v[32:35], 0
    v_mfma_f32_16x16x32_bf16 v[16:19], v[68:71], v[36:39], v[16:19]
    v_mfma_f32_16x16x32_bf16 v[16:19], v[72:75], v[40:43], v[16:19]
    v_mfma_f32_16x16x32_bf16 v[16:19], v[76:79], v[44:47], v[16:19]
    v_mfma_f32_16x16x32_bf16 v[16:19], v[80:83], v[48:51], v[16:19]
    v_mfma_f32_16x16x32_bf16 v[16:19], v[84:87], v[52:55], v[16:19]
    v_mfma_f32_16x16x32_bf16 v[16:19], v[88:91], v[56:59], v[16:19]
    v_mfma_f32_16x16x32_bf16 v[16:19], v[92:95], v[60:63], v[16:19]
    buffer_load_dwordx4 v[64:67], v12, s[4:7], s80 offen offset:0 nt
    buffer_load_dwordx4 v[68:71], v12, s[4:7], s80 offen offset:64 nt
    buffer_load_dwordx4 v[72:75], v12, s[4:7], s80 offen offset:128 nt
    buffer_load_dwordx4 v[76:79], v12, s[4:7], s80 offen offset:192 nt
    buffer_load_dwordx4 v[80:83], v12, s[4:7], s80 offen offset:256 nt
    buffer_load_dwordx4 v[84:87], v12, s[4:7], s80 offen offset:320 nt
    buffer_load_dwordx4 v[88:91], v12, s[4:7], s80 offen offset:384 nt
    buffer_load_dwordx4 v[92:95], v12, s[4:7], s80 offen offset:448 nt
    v_cvt_pk_bf16_f32 v0, v16, v17
    v_cvt_pk_bf16_f32 v4, v18, v19
    v_lshlrev_b32 v16, 16, v0
    v_and_b32 v17, 0xffff0000, v0
    v_lshlrev_b32 v18, 16, v4
    v_and_b32 v19, 0xffff0000, v4
    v_max3_f32 v0, v16, v17, v18
    v_max_f32 v0, v0, v19
    v_mov_b32 v4, v0
    s_nop 1
    v_permlane16_swap_b32 v0, v4
    v_max_f32 v0, v0, v4
    v_mov_b32 v4, v0
    s_nop 1
    v_permlane32_swap_b32 v0, v4
    v_max_f32 v0, v0, v4
    v_mul_f32 v0, s64, v0
    v_ceil_f32 v0, v0
    v_max_f32 v0, v0, v14
    v_sub_f32 v4, v14, v0
    v_exp_f32 v4, v4
    v_mov_b32 v14, v0
    v_fma_f32 v16, v16, s64, -v0
    v_fma_f32 v17, v17, s64, -v0
    v_fma_f32 v18, v18, s64, -v0
    v_fma_f32 v19, v19, s64, -v0
    v_exp_f32 v16, v16
    v_exp_f32 v17, v17
    v_exp_f32 v18, v18
    v_exp_f32 v19, v19
    v_mul_f32_dpp v20, v4, v20 quad_perm:[0,0,2,2] row_mask:0xf bank_mask:0xf
    v_mul_f32_dpp v21, v4, v21 quad_perm:[1,1,3,3] row_mask:0xf bank_mask:0xf
    v_mul_f32_dpp v22, v4, v22 quad_perm:[0,0,2,2] row_mask:0xf bank_mask:0xf
    v_mul_f32_dpp v23, v4, v23 quad_perm:[1,1,3,3] row_mask:0xf bank_mask:0xf
    v_mul_f32_dpp v24, v4, v24 quad_perm:[0,0,2,2] row_mask:0xf bank_mask:0xf
    v_mul_f32_dpp v25, v4, v25 quad_perm:[1,1,3,3] row_mask:0xf bank_mask:0xf
    v_mul_f32_dpp v26, v4, v26 quad_perm:[0,0,2,2] row_mask:0xf bank_mask:0xf
    v_mul_f32_dpp v27, v4, v27 quad_perm:[1,1,3,3] row_mask:0xf bank_mask:0xf
    v_add_f32 v6, v16, v17
    v_add_f32 v7, v18, v19
    v_add_f32 v6, v6, v7
    v_fma_f32 v15, v15, v4, v6
    v_cvt_pk_bf16_f32 v16, v16, v16
    v_cvt_pk_bf16_f32 v17, v17, v17
    v_cvt_pk_bf16_f32 v18, v18, v18
    v_cvt_pk_bf16_f32 v19, v19, v19
    s_waitcnt vmcnt(8)
    v_and_b32 v28, v16, v8
    v_and_b32 v29, v16, v9
    v_and_b32 v30, v16, v10
    v_and_b32 v31, v16, v11
    s_nop 1
    v_mfma_f32_16x16x32_bf16 v[20:23], v[28:31], v[96:99], v[20:23]
    v_mfma_f32_16x16x32_bf16 v[24:27], v[28:31], v[100:103], v[24:27]
    v_and_b32 v28, v17, v8
    v_and_b32 v29, v17, v9
    v_and_b32 v30, v17, v10
    v_and_b32 v31, v17, v11
    s_nop 1
    v_mfma_f32_16x16x32_bf16 v[20:23], v[28:31], v[104:107], v[20:23]
    v_mfma_f32_16x16x32_bf16 v[24:27], v[28:31], v[108:111], v[24:27]
    v_and_b32 v28, v18, v8
    v_and_b32 v29, v18, v9
    v_and_b32 v30, v18, v10
    v_and_b32 v31, v18, v11
    s_nop 1
    v_mfma_f32_16x16x32_bf16 v[20:23], v[28:31], v[112:115], v[20:23]
    v_mfma_f32_16x16x32_bf16 v[24:27], v[28:31], v[116:119], v[24:27]
    v_and_b32 v28, v19, v8
    v_and_b32 v29, v19, v9
    v_and_b32 v30, v19, v10
    v_and_b32 v31, v19, v11
    s_nop 1
    v_mfma_f32_16x16x32_bf16 v[20:23], v[28:31], v[120:123], v[20:23]
    v_mfma_f32_16x16x32_bf16 v[24:27], v[28:31], v[124:127], v[24:27]
    buffer_load_dwordx4 v[96:99], v13, s[8:11], s80 offen offset:0 nt
    buffer_load_dwordx4 v[100:103], v13, s[8:11], s80 offen offset:256 nt
    buffer_load_dwordx4 v[104:107], v13, s[8:11], s80 offen offset:512 nt
    buffer_load_dwordx4 v[108:111], v13, s[8:11], s80 offen offset:768 nt
    buffer_load_dwordx4 v[112:115], v13, s[8:11], s80 offen offset:1024 nt
    buffer_load_dwordx4 v[116:119], v13, s[8:11], s80 offen offset:1280 nt
    buffer_load_dwordx4 v[120:123], v13, s[8:11], s80 offen offset:1536 nt
    buffer_load_dwordx4 v[124:127], v13, s[8:11], s80 offen offset:1792 nt
    s_add_u32 s80, s80, 524288
    v_mfma_f32_16x16x32_bf16 v[16:19], a[128:131], v[32:35], 0
    v_mfma_f32_16x16x32_bf16 v[16:19], a[132:135], v[36:39], v[16:19]
    v_mfma_f32_16x16x32_bf16 v[16:19], a[136:139], v[40:43], v[16:19]
    v_mfma_f32_16x16x32_bf16 v[16:19], a[140:143], v[44:47], v[16:19]
    v_mfma_f32_16x16x32_bf16 v[16:19], a[144:147], v[48:51], v[16:19]
    v_mfma_f32_16x16x32_bf16 v[16:19], a[148:151], v[52:55], v[16:19]
    v_mfma_f32_16x16x32_bf16 v[16:19], a[152:155], v[56:59], v[16:19]
    v_mfma_f32_16x16x32_bf16 v[16:19], a[156:159], v[60:63], v[16:19]
    s_nop 7
    v_cvt_pk_bf16_f32 v0, v16, v17
    v_cvt_pk_bf16_f32 v4, v18, v19
    v_lshlrev_b32 v16, 16, v0
    v_and_b32 v17, 0xffff0000, v0
    v_lshlrev_b32 v18, 16, v4
    v_and_b32 v19, 0xffff0000, v4
    v_max3_f32 v0, v16, v17, v18
    v_max_f32 v0, v0, v19
    v_mov_b32 v4, v0
    s_nop 1
    v_permlane16_swap_b32 v0, v4
    v_max_f32 v0, v0, v4
    v_mov_b32 v4, v0
    s_nop 1
    v_permlane32_swap_b32 v0, v4
    v_max_f32 v0, v0, v4
    v_mul_f32 v0, s64, v0
    v_ceil_f32 v0, v0
    v_max_f32 v0, v0, v14
    v_sub_f32 v4, v14, v0
    v_exp_f32 v4, v4
    v_mov_b32 v14, v0
    v_fma_f32 v16, v16, s64, -v0
    v_fma_f32 v17, v17, s64, -v0
    v_fma_f32 v18, v18, s64, -v0
    v_fma_f32 v19, v19, s64, -v0
    v_exp_f32 v16, v16
    v_exp_f32 v17, v17
    v_exp_f32 v18, v18
    v_exp_f32 v19, v19
    v_mul_f32_dpp v20, v4, v20 quad_perm:[0,0,2,2] row_mask:0xf bank_mask:0xf
    v_mul_f32_dpp v21, v4, v21 quad_perm:[1,1,3,3] row_mask:0xf bank_mask:0xf
    v_mul_f32_dpp v22, v4, v22 quad_perm:[0,0,2,2] row_mask:0xf bank_mask:0xf
    v_mul_f32_dpp v23, v4, v23 quad_perm:[1,1,3,3] row_mask:0xf bank_mask:0xf
    v_mul_f32_dpp v24, v4, v24 quad_perm:[0,0,2,2] row_mask:0xf bank_mask:0xf
    v_mul_f32_dpp v25, v4, v25 quad_perm:[1,1,3,3] row_mask:0xf bank_mask:0xf
    v_mul_f32_dpp v26, v4, v26 quad_perm:[0,0,2,2] row_mask:0xf bank_mask:0xf
    v_mul_f32_dpp v27, v4, v27 quad_perm:[1,1,3,3] row_mask:0xf bank_mask:0xf
    v_add_f32 v6, v16, v17
    v_add_f32 v7, v18, v19
    v_add_f32 v6, v6, v7
    v_fma_f32 v15, v15, v4, v6
    v_cvt_pk_bf16_f32 v16, v16, v16
    v_cvt_pk_bf16_f32 v17, v17, v17
    v_cvt_pk_bf16_f32 v18, v18, v18
    v_cvt_pk_bf16_f32 v19, v19, v19
    v_and_b32 v28, v16, v8
    v_and_b32 v29, v16, v9
    v_and_b32 v30, v16, v10
    v_and_b32 v31, v16, v11
    s_nop 1
    v_mfma_f32_16x16x32_bf16 v[20:23], v[28:31], a[160:163], v[20:23]
    v_mfma_f32_16x16x32_bf16 v[24:27], v[28:31], a[164:167], v[24:27]
    v_and_b32 v28, v17, v8
    v_and_b32 v29, v17, v9
    v_and_b32 v30, v17, v10
    v_and_b32 v31, v17, v11
    s_nop 1
    v_mfma_f32_16x16x32_bf16 v[20:23], v[28:31], a[168:171], v[20:23]
    v_mfma_f32_16x16x32_bf16 v[24:27], v[28:31], a[172:175], v[24:27]
    v_and_b32 v28, v18, v8
    v_and_b32 v29, v18, v9
    v_and_b32 v30, v18, v10
    v_and_b32 v31, v18, v11
    s_nop 1
    v_mfma_f32_16x16x32_bf16 v[20:23], v[28:31], a[176:179], v[20:23]
    v_mfma_f32_16x16x32_bf16 v[24:27], v[28:31], a[180:183], v[24:27]
    v_and_b32 v28, v19, v8
    v_and_b32 v29, v19, v9
    v_and_b32 v30, v19, v10
    v_and_b32 v31, v19, v11
    s_nop 1
    v_mfma_f32_16x16x32_bf16 v[20:23], v[28:31], a[184:187], v[20:23]
    v_mfma_f32_16x16x32_bf16 v[24:27], v[28:31], a[188:191], v[24:27]
    v_mfma_f32_16x16x32_bf16 v[16:19], a[192:195], v[32:35], 0
    v_mfma_f32_16x16x32_bf16 v[16:19], a[196:199], v[36:39], v[16:19]
    v_mfma_f32_16x16x32_bf16 v[16:19], a[200:203], v[40:43], v[16:19]
    v_mfma_f32_16x16x32_bf16 v[16:19], a[204:207], v[44:47], v[16:19]
    v_mfma_f32_16x16x32_bf16 v[16:19], a[208:211], v[48:51], v[16:19]
    v_mfma_f32_16x16x32_bf16 v[16:19], a[212:215], v[52:55], v[16:19]
    v_mfma_f32_16x16x32_bf16 v[16:19], a[216:219], v[56:59], v[16:19]
    v_mfma_f32_16x16x32_bf16 v[16:19], a[220:223], v[60:63], v[16:19]
    s_nop 7
    v_cvt_pk_bf16_f32 v0, v16, v17
    v_cvt_pk_bf16_f32 v4, v18, v19
    v_lshlrev_b32 v16, 16, v0
    v_and_b32 v17, 0xffff0000, v0
    v_lshlrev_b32 v18, 16, v4
    v_and_b32 v19, 0xffff0000, v4
    v_max3_f32 v0, v16, v17, v18
    v_max_f32 v0, v0, v19
    v_mov_b32 v4, v0
    s_nop 1
    v_permlane16_swap_b32 v0, v4
    v_max_f32 v0, v0, v4
    v_mov_b32 v4, v0
    s_nop 1
    v_permlane32_swap_b32 v0, v4
    v_max_f32 v0, v0, v4
    v_mul_f32 v0, s64, v0
    v_ceil_f32 v0, v0
    v_max_f32 v0, v0, v14
    v_sub_f32 v4, v14, v0
    v_exp_f32 v4, v4
    v_mov_b32 v14, v0
    v_fma_f32 v16, v16, s64, -v0
    v_fma_f32 v17, v17, s64, -v0
    v_fma_f32 v18, v18, s64, -v0
    v_fma_f32 v19, v19, s64, -v0
    v_exp_f32 v16, v16
    v_exp_f32 v17, v17
    v_exp_f32 v18, v18
    v_exp_f32 v19, v19
    v_mul_f32_dpp v20, v4, v20 quad_perm:[0,0,2,2] row_mask:0xf bank_mask:0xf
    v_mul_f32_dpp v21, v4, v21 quad_perm:[1,1,3,3] row_mask:0xf bank_mask:0xf
    v_mul_f32_dpp v22, v4, v22 quad_perm:[0,0,2,2] row_mask:0xf bank_mask:0xf
    v_mul_f32_dpp v23, v4, v23 quad_perm:[1,1,3,3] row_mask:0xf bank_mask:0xf
    v_mul_f32_dpp v24, v4, v24 quad_perm:[0,0,2,2] row_mask:0xf bank_mask:0xf
    v_mul_f32_dpp v25, v4, v25 quad_perm:[1,1,3,3] row_mask:0xf bank_mask:0xf
    v_mul_f32_dpp v26, v4, v26 quad_perm:[0,0,2,2] row_mask:0xf bank_mask:0xf
    v_mul_f32_dpp v27, v4, v27 quad_perm:[1,1,3,3] row_mask:0xf bank_mask:0xf
    v_add_f32 v6, v16, v17
    v_add_f32 v7, v18, v19
    v_add_f32 v6, v6, v7
    v_fma_f32 v15, v15, v4, v6
    v_cvt_pk_bf16_f32 v16, v16, v16
    v_cvt_pk_bf16_f32 v17, v17, v17
    v_cvt_pk_bf16_f32 v18, v18, v18
    v_cvt_pk_bf16_f32 v19, v19, v19
    v_and_b32 v28, v16, v8
    v_and_b32 v29, v16, v9
    v_and_b32 v30, v16, v10
    v_and_b32 v31, v16, v11
    s_nop 1
    v_mfma_f32_16x16x32_bf16 v[20:23], v[28:31], a[224:227], v[20:23]
    v_mfma_f32_16x16x32_bf16 v[24:27], v[28:31], a[228:231], v[24:27]
    v_and_b32 v28, v17, v8
    v_and_b32 v29, v17, v9
    v_and_b32 v30, v17, v10
    v_and_b32 v31, v17, v11
    s_nop 1
    v_mfma_f32_16x16x32_bf16 v[20:23], v[28:31], a[232:235], v[20:23]
    v_mfma_f32_16x16x32_bf16 v[24:27], v[28:31], a[236:239], v[24:27]
    v_and_b32 v28, v18, v8
    v_and_b32 v29, v18, v9
    v_and_b32 v30, v18, v10
    v_and_b32 v31, v18, v11
    s_nop 1
    v_mfma_f32_16x16x32_bf16 v[20:23], v[28:31], a[240:243], v[20:23]
    v_mfma_f32_16x16x32_bf16 v[24:27], v[28:31], a[244:247], v[24:27]
    v_and_b32 v28, v19, v8
    v_and_b32 v29, v19, v9
    v_and_b32 v30, v19, v10
    v_and_b32 v31, v19, v11
    s_nop 1
    v_mfma_f32_16x16x32_bf16 v[20:23], v[28:31], a[248:251], v[20:23]
    v_mfma_f32_16x16x32_bf16 v[24:27], v[28:31], a[252:255], v[24:27]
    s_waitcnt vmcnt(8)
    v_mfma_f32_16x16x32_bf16 v[16:19], v[64:67], v[32:35], 0
    v_mfma_f32_16x16x32_bf16 v[16:19], v[68:71], v[36:39], v[16:19]
    v_mfma_f32_16x16x32_bf16 v[16:19], v[72:75], v[40:43], v[16:19]
    v_mfma_f32_16x16x32_bf16 v[16:19], v[76:79], v[44:47], v[16:19]
    v_mfma_f32_16x16x32_bf16 v[16:19], v[80:83], v[48:51], v[16:19]
    v_mfma_f32_16x16x32_bf16 v[16:19], v[84:87], v[52:55], v[16:19]
    v_mfma_f32_16x16x32_bf16 v[16:19], v[88:91], v[56:59], v[16:19]
    v_mfma_f32_16x16x32_bf16 v[16:19], v[92:95], v[60:63], v[16:19]
    buffer_load_dwordx4 v[64:67], v12, s[4:7], s80 offen offset:0 nt
    buffer_load_dwordx4 v[68:71], v12, s[4:7], s80 offen offset:64 nt
    buffer_load_dwordx4 v[72:75], v12, s[4:7], s80 offen offset:128 nt
    buffer_load_dwordx4 v[76:79], v12, s[4:7], s80 offen offset:192 nt
    buffer_load_dwordx4 v[80:83], v12, s[4:7], s80 offen offset:256 nt
    buffer_load_dwordx4 v[84:87], v12, s[4:7], s80 offen offset:320 nt
    buffer_load_dwordx4 v[88:91], v12, s[4:7], s80 offen offset:384 nt
    buffer_load_dwordx4 v[92:95], v12, s[4:7], s80 offen offset:448 nt
    v_cvt_pk_bf16_f32 v0, v16, v17
    v_cvt_pk_bf16_f32 v4, v18, v19
    v_lshlrev_b32 v16, 16, v0
    v_and_b32 v17, 0xffff0000, v0
    v_lshlrev_b32 v18, 16, v4
    v_and_b32 v19, 0xffff0000, v4
    v_max3_f32 v0, v16, v17, v18
    v_max_f32 v0, v0, v19
    v_mov_b32 v4, v0
    s_nop 1
    v_permlane16_swap_b32 v0, v4
    v_max_f32 v0, v0, v4
    v_mov_b32 v4, v0
    s_nop 1
    v_permlane32_swap_b32 v0, v4
    v_max_f32 v0, v0, v4
    v_mul_f32 v0, s64, v0
    v_ceil_f32 v0, v0
    v_max_f32 v0, v0, v14
    v_sub_f32 v4, v14, v0
    v_exp_f32 v4, v4
    v_mov_b32 v14, v0
    v_fma_f32 v16, v16, s64, -v0
    v_fma_f32 v17, v17, s64, -v0
    v_fma_f32 v18, v18, s64, -v0
    v_fma_f32 v19, v19, s64, -v0
    v_exp_f32 v16, v16
    v_exp_f32 v17, v17
    v_exp_f32 v18, v18
    v_exp_f32 v19, v19
    v_mul_f32_dpp v20, v4, v20 quad_perm:[0,0,2,2] row_mask:0xf bank_mask:0xf
    v_mul_f32_dpp v21, v4, v21 quad_perm:[1,1,3,3] row_mask:0xf bank_mask:0xf
    v_mul_f32_dpp v22, v4, v22 quad_perm:[0,0,2,2] row_mask:0xf bank_mask:0xf
    v_mul_f32_dpp v23, v4, v23 quad_perm:[1,1,3,3] row_mask:0xf bank_mask:0xf
    v_mul_f32_dpp v24, v4, v24 quad_perm:[0,0,2,2] row_mask:0xf bank_mask:0xf
    v_mul_f32_dpp v25, v4, v25 quad_perm:[1,1,3,3] row_mask:0xf bank_mask:0xf
    v_mul_f32_dpp v26, v4, v26 quad_perm:[0,0,2,2] row_mask:0xf bank_mask:0xf
    v_mul_f32_dpp v27, v4, v27 quad_perm:[1,1,3,3] row_mask:0xf bank_mask:0xf
    v_add_f32 v6, v16, v17
    v_add_f32 v7, v18, v19
    v_add_f32 v6, v6, v7
    v_fma_f32 v15, v15, v4, v6
    v_cvt_pk_bf16_f32 v16, v16, v16
    v_cvt_pk_bf16_f32 v17, v17, v17
    v_cvt_pk_bf16_f32 v18, v18, v18
    v_cvt_pk_bf16_f32 v19, v19, v19
    s_waitcnt vmcnt(8)
    v_and_b32 v28, v16, v8
    v_and_b32 v29, v16, v9
    v_and_b32 v30, v16, v10
    v_and_b32 v31, v16, v11
    s_nop 1
    v_mfma_f32_16x16x32_bf16 v[20:23], v[28:31], v[96:99], v[20:23]
    v_mfma_f32_16x16x32_bf16 v[24:27], v[28:31], v[100:103], v[24:27]
    v_and_b32 v28, v17, v8
    v_and_b32 v29, v17, v9
    v_and_b32 v30, v17, v10
    v_and_b32 v31, v17, v11
    s_nop 1
    v_mfma_f32_16x16x32_bf16 v[20:23], v[28:31], v[104:107], v[20:23]
    v_mfma_f32_16x16x32_bf16 v[24:27], v[28:31], v[108:111], v[24:27]
    v_and_b32 v28, v18, v8
    v_and_b32 v29, v18, v9
    v_and_b32 v30, v18, v10
    v_and_b32 v31, v18, v11
    s_nop 1
    v_mfma_f32_16x16x32_bf16 v[20:23], v[28:31], v[112:115], v[20:23]
    v_mfma_f32_16x16x32_bf16 v[24:27], v[28:31], v[116:119], v[24:27]
    v_and_b32 v28, v19, v8
    v_and_b32 v29, v19, v9
    v_and_b32 v30, v19, v10
    v_and_b32 v31, v19, v11
    s_nop 1
    v_mfma_f32_16x16x32_bf16 v[20:23], v[28:31], v[120:123], v[20:23]
    v_mfma_f32_16x16x32_bf16 v[24:27], v[28:31], v[124:127], v[24:27]
    buffer_load_dwordx4 v[96:99], v13, s[8:11], s80 offen offset:0 nt
    buffer_load_dwordx4 v[100:103], v13, s[8:11], s80 offen offset:256 nt
    buffer_load_dwordx4 v[104:107], v13, s[8:11], s80 offen offset:512 nt
    buffer_load_dwordx4 v[108:111], v13, s[8:11], s80 offen offset:768 nt
    buffer_load_dwordx4 v[112:115], v13, s[8:11], s80 offen offset:1024 nt
    buffer_load_dwordx4 v[116:119], v13, s[8:11], s80 offen offset:1280 nt
    buffer_load_dwordx4 v[120:123], v13, s[8:11], s80 offen offset:1536 nt
    buffer_load_dwordx4 v[124:127], v13, s[8:11], s80 offen offset:1792 nt
    s_add_u32 s80, s80, 524288
    s_waitcnt lgkmcnt(0)
    v_mfma_f32_16x16x32_bf16 v[16:19], v[128:131], v[32:35], 0
    v_mfma_f32_16x16x32_bf16 v[16:19], v[132:135], v[36:39], v[16:19]
    v_mfma_f32_16x16x32_bf16 v[16:19], v[136:139], v[40:43], v[16:19]
    v_mfma_f32_16x16x32_bf16 v[16:19], v[140:143], v[44:47], v[16:19]
    v_mfma_f32_16x16x32_bf16 v[16:19], v[144:147], v[48:51], v[16:19]
    v_mfma_f32_16x16x32_bf16 v[16:19], v[148:151], v[52:55], v[16:19]
    v_mfma_f32_16x16x32_bf16 v[16:19], v[152:155], v[56:59], v[16:19]
    v_mfma_f32_16x16x32_bf16 v[16:19], v[156:159], v[60:63], v[16:19]
    s_nop 7
    v_cvt_pk_bf16_f32 v0, v16, v17
    v_cvt_pk_bf16_f32 v4, v18, v19
    v_lshlrev_b32 v16, 16, v0
    v_and_b32 v17, 0xffff0000, v0
    v_lshlrev_b32 v18, 16, v4
    v_and_b32 v19, 0xffff0000, v4
    v_max3_f32 v0, v16, v17, v18
    v_max_f32 v0, v0, v19
    v_mov_b32 v4, v0
    s_nop 1
    v_permlane16_swap_b32 v0, v4
    v_max_f32 v0, v0, v4
    v_mov_b32 v4, v0
    s_nop 1
    v_permlane32_swap_b32 v0, v4
    v_max_f32 v0, v0, v4
    v_mul_f32 v0, s64, v0
    v_ceil_f32 v0, v0
    v_max_f32 v0, v0, v14
    v_sub_f32 v4, v14, v0
    v_exp_f32 v4, v4
    v_mov_b32 v14, v0
    v_fma_f32 v16, v16, s64, -v0
    v_fma_f32 v17, v17, s64, -v0
    v_fma_f32 v18, v18, s64, -v0
    v_fma_f32 v19, v19, s64, -v0
    v_exp_f32 v16, v16
    v_exp_f32 v17, v17
    v_exp_f32 v18, v18
    v_exp_f32 v19, v19
    v_mul_f32_dpp v20, v4, v20 quad_perm:[0,0,2,2] row_mask:0xf bank_mask:0xf
    v_mul_f32_dpp v21, v4, v21 quad_perm:[1,1,3,3] row_mask:0xf bank_mask:0xf
    v_mul_f32_dpp v22, v4, v22 quad_perm:[0,0,2,2] row_mask:0xf bank_mask:0xf
    v_mul_f32_dpp v23, v4, v23 quad_perm:[1,1,3,3] row_mask:0xf bank_mask:0xf
    v_mul_f32_dpp v24, v4, v24 quad_perm:[0,0,2,2] row_mask:0xf bank_mask:0xf
    v_mul_f32_dpp v25, v4, v25 quad_perm:[1,1,3,3] row_mask:0xf bank_mask:0xf
    v_mul_f32_dpp v26, v4, v26 quad_perm:[0,0,2,2] row_mask:0xf bank_mask:0xf
    v_mul_f32_dpp v27, v4, v27 quad_perm:[1,1,3,3] row_mask:0xf bank_mask:0xf
    v_add_f32 v6, v16, v17
    v_add_f32 v7, v18, v19
    v_add_f32 v6, v6, v7
    v_fma_f32 v15, v15, v4, v6
    v_cvt_pk_bf16_f32 v16, v16, v16
    v_cvt_pk_bf16_f32 v17, v17, v17
    v_cvt_pk_bf16_f32 v18, v18, v18
    v_cvt_pk_bf16_f32 v19, v19, v19
    v_and_b32 v28, v16, v8
    v_and_b32 v29, v16, v9
    v_and_b32 v30, v16, v10
    v_and_b32 v31, v16, v11
    s_nop 1
    v_mfma_f32_16x16x32_bf16 v[20:23], v[28:31], v[160:163], v[20:23]
    v_mfma_f32_16x16x32_bf16 v[24:27], v[28:31], v[164:167], v[24:27]
    v_and_b32 v28, v17, v8
    v_and_b32 v29, v17, v9
    v_and_b32 v30, v17, v10
    v_and_b32 v31, v17, v11
    s_nop 1
    v_mfma_f32_16x16x32_bf16 v[20:23], v[28:31], v[168:171], v[20:23]
    v_mfma_f32_16x16x32_bf16 v[24:27], v[28:31], v[172:175], v[24:27]
    v_and_b32 v28, v18, v8
    v_and_b32 v29, v18, v9
    v_and_b32 v30, v18, v10
    v_and_b32 v31, v18, v11
    s_nop 1
    v_mfma_f32_16x16x32_bf16 v[20:23], v[28:31], v[176:179], v[20:23]
    v_mfma_f32_16x16x32_bf16 v[24:27], v[28:31], v[180:183], v[24:27]
    v_and_b32 v28, v19, v8
    v_and_b32 v29, v19, v9
    v_and_b32 v30, v19, v10
    v_and_b32 v31, v19, v11
    s_nop 1
    v_mfma_f32_16x16x32_bf16 v[20:23], v[28:31], v[184:187], v[20:23]
    v_mfma_f32_16x16x32_bf16 v[24:27], v[28:31], v[188:191], v[24:27]
    s_waitcnt lgkmcnt(0)
    v_mfma_f32_16x16x32_bf16 v[16:19], v[192:195], v[32:35], 0
    v_mfma_f32_16x16x32_bf16 v[16:19], v[196:199], v[36:39], v[16:19]
    v_mfma_f32_16x16x32_bf16 v[16:19], v[200:203], v[40:43], v[16:19]
    v_mfma_f32_16x16x32_bf16 v[16:19], v[204:207], v[44:47], v[16:19]
    v_mfma_f32_16x16x32_bf16 v[16:19], v[208:211], v[48:51], v[16:19]
    v_mfma_f32_16x16x32_bf16 v[16:19], v[212:215], v[52:55], v[16:19]
    v_mfma_f32_16x16x32_bf16 v[16:19], v[216:219], v[56:59], v[16:19]
    v_mfma_f32_16x16x32_bf16 v[16:19], v[220:223], v[60:63], v[16:19]
    s_nop 7
    v_cvt_pk_bf16_f32 v0, v16, v17
    v_cvt_pk_bf16_f32 v4, v18, v19
    v_lshlrev_b32 v16, 16, v0
    v_and_b32 v17, 0xffff0000, v0
    v_lshlrev_b32 v18, 16, v4
    v_and_b32 v19, 0xffff0000, v4
    v_max3_f32 v0, v16, v17, v18
    v_max_f32 v0, v0, v19
    v_mov_b32 v4, v0
    s_nop 1
    v_permlane16_swap_b32 v0, v4
    v_max_f32 v0, v0, v4
    v_mov_b32 v4, v0
    s_nop 1
    v_permlane32_swap_b32 v0, v4
    v_max_f32 v0, v0, v4
    v_mul_f32 v0, s64, v0
    v_ceil_f32 v0, v0
    v_max_f32 v0, v0, v14
    v_sub_f32 v4, v14, v0
    v_exp_f32 v4, v4
    v_mov_b32 v14, v0
    v_fma_f32 v16, v16, s64, -v0
    v_fma_f32 v17, v17, s64, -v0
    v_fma_f32 v18, v18, s64, -v0
    v_fma_f32 v19, v19, s64, -v0
    v_exp_f32 v16, v16
    v_exp_f32 v17, v17
    v_exp_f32 v18, v18
    v_exp_f32 v19, v19
    v_mul_f32_dpp v20, v4, v20 quad_perm:[0,0,2,2] row_mask:0xf bank_mask:0xf
    v_mul_f32_dpp v21, v4, v21 quad_perm:[1,1,3,3] row_mask:0xf bank_mask:0xf
    v_mul_f32_dpp v22, v4, v22 quad_perm:[0,0,2,2] row_mask:0xf bank_mask:0xf
    v_mul_f32_dpp v23, v4, v23 quad_perm:[1,1,3,3] row_mask:0xf bank_mask:0xf
    v_mul_f32_dpp v24, v4, v24 quad_perm:[0,0,2,2] row_mask:0xf bank_mask:0xf
    v_mul_f32_dpp v25, v4, v25 quad_perm:[1,1,3,3] row_mask:0xf bank_mask:0xf
    v_mul_f32_dpp v26, v4, v26 quad_perm:[0,0,2,2] row_mask:0xf bank_mask:0xf
    v_mul_f32_dpp v27, v4, v27 quad_perm:[1,1,3,3] row_mask:0xf bank_mask:0xf
    v_add_f32 v6, v16, v17
    v_add_f32 v7, v18, v19
    v_add_f32 v6, v6, v7
    v_fma_f32 v15, v15, v4, v6
    v_cvt_pk_bf16_f32 v16, v16, v16
    v_cvt_pk_bf16_f32 v17, v17, v17
    v_cvt_pk_bf16_f32 v18, v18, v18
    v_cvt_pk_bf16_f32 v19, v19, v19
    v_and_b32 v28, v16, v8
    v_and_b32 v29, v16, v9
    v_and_b32 v30, v16, v10
    v_and_b32 v31, v16, v11
    s_nop 1
    v_mfma_f32_16x16x32_bf16 v[20:23], v[28:31], v[224:227], v[20:23]
    v_mfma_f32_16x16x32_bf16 v[24:27], v[28:31], v[228:231], v[24:27]
    v_and_b32 v28, v17, v8
    v_and_b32 v29, v17, v9
    v_and_b32 v30, v17, v10
    v_and_b32 v31, v17, v11
    s_nop 1
    v_mfma_f32_16x16x32_bf16 v[20:23], v[28:31], v[232:235], v[20:23]
    v_mfma_f32_16x16x32_bf16 v[24:27], v[28:31], v[236:239], v[24:27]
    v_and_b32 v28, v18, v8
    v_and_b32 v29, v18, v9
    v_and_b32 v30, v18, v10
    v_and_b32 v31, v18, v11
    s_nop 1
    v_mfma_f32_16x16x32_bf16 v[20:23], v[28:31], v[240:243], v[20:23]
    v_mfma_f32_16x16x32_bf16 v[24:27], v[28:31], v[244:247], v[24:27]
    v_and_b32 v28, v19, v8
    v_and_b32 v29, v19, v9
    v_and_b32 v30, v19, v10
    v_and_b32 v31, v19, v11
    s_nop 1
    v_mfma_f32_16x16x32_bf16 v[20:23], v[28:31], v[248:251], v[20:23]
    v_mfma_f32_16x16x32_bf16 v[24:27], v[28:31], v[252:255], v[24:27]
    s_waitcnt vmcnt(8)
    v_mfma_f32_16x16x32_bf16 v[16:19], v[64:67], v[32:35], 0
    v_mfma_f32_16x16x32_bf16 v[16:19], v[68:71], v[36:39], v[16:19]
    v_mfma_f32_16x16x32_bf16 v[16:19], v[72:75], v[40:43], v[16:19]
    v_mfma_f32_16x16x32_bf16 v[16:19], v[76:79], v[44:47], v[16:19]
    v_mfma_f32_16x16x32_bf16 v[16:19], v[80:83], v[48:51], v[16:19]
    v_mfma_f32_16x16x32_bf16 v[16:19], v[84:87], v[52:55], v[16:19]
    v_mfma_f32_16x16x32_bf16 v[16:19], v[88:91], v[56:59], v[16:19]
    v_mfma_f32_16x16x32_bf16 v[16:19], v[92:95], v[60:63], v[16:19]
    buffer_load_dwordx4 v[64:67], v12, s[4:7], s80 offen offset:0 nt
    buffer_load_dwordx4 v[68:71], v12, s[4:7], s80 offen offset:64 nt
    buffer_load_dwordx4 v[72:75], v12, s[4:7], s80 offen offset:128 nt
    buffer_load_dwordx4 v[76:79], v12, s[4:7], s80 offen offset:192 nt
    buffer_load_dwordx4 v[80:83], v12, s[4:7], s80 offen offset:256 nt
    buffer_load_dwordx4 v[84:87], v12, s[4:7], s80 offen offset:320 nt
    buffer_load_dwordx4 v[88:91], v12, s[4:7], s80 offen offset:384 nt
    buffer_load_dwordx4 v[92:95], v12, s[4:7], s80 offen offset:448 nt
    v_cvt_pk_bf16_f32 v0, v16, v17
    v_cvt_pk_bf16_f32 v4, v18, v19
    v_lshlrev_b32 v16, 16, v0
    v_and_b32 v17, 0xffff0000, v0
    v_lshlrev_b32 v18, 16, v4
    v_and_b32 v19, 0xffff0000, v4
    v_max3_f32 v0, v16, v17, v18
    v_max_f32 v0, v0, v19
    v_mov_b32 v4, v0
    s_nop 1
    v_permlane16_swap_b32 v0, v4
    v_max_f32 v0, v0, v4
    v_mov_b32 v4, v0
    s_nop 1
    v_permlane32_swap_b32 v0, v4
    v_max_f32 v0, v0, v4
    v_mul_f32 v0, s64, v0
    v_ceil_f32 v0, v0
    v_max_f32 v0, v0, v14
    v_sub_f32 v4, v14, v0
    v_exp_f32 v4, v4
    v_mov_b32 v14, v0
    v_fma_f32 v16, v16, s64, -v0
    v_fma_f32 v17, v17, s64, -v0
    v_fma_f32 v18, v18, s64, -v0
    v_fma_f32 v19, v19, s64, -v0
    v_exp_f32 v16, v16
    v_exp_f32 v17, v17
    v_exp_f32 v18, v18
    v_exp_f32 v19, v19
    v_mul_f32_dpp v20, v4, v20 quad_perm:[0,0,2,2] row_mask:0xf bank_mask:0xf
    v_mul_f32_dpp v21, v4, v21 quad_perm:[1,1,3,3] row_mask:0xf bank_mask:0xf
    v_mul_f32_dpp v22, v4, v22 quad_perm:[0,0,2,2] row_mask:0xf bank_mask:0xf
    v_mul_f32_dpp v23, v4, v23 quad_perm:[1,1,3,3] row_mask:0xf bank_mask:0xf
    v_mul_f32_dpp v24, v4, v24 quad_perm:[0,0,2,2] row_mask:0xf bank_mask:0xf
    v_mul_f32_dpp v25, v4, v25 quad_perm:[1,1,3,3] row_mask:0xf bank_mask:0xf
    v_mul_f32_dpp v26, v4, v26 quad_perm:[0,0,2,2] row_mask:0xf bank_mask:0xf
    v_mul_f32_dpp v27, v4, v27 quad_perm:[1,1,3,3] row_mask:0xf bank_mask:0xf
    v_add_f32 v6, v16, v17
    v_add_f32 v7, v18, v19
    v_add_f32 v6, v6, v7
    v_fma_f32 v15, v15, v4, v6
    v_cvt_pk_bf16_f32 v16, v16, v16
    v_cvt_pk_bf16_f32 v17, v17, v17
    v_cvt_pk_bf16_f32 v18, v18, v18
    v_cvt_pk_bf16_f32 v19, v19, v19
    s_waitcnt vmcnt(8)
    v_and_b32 v28, v16, v8
    v_and_b32 v29, v16, v9
    v_and_b32 v30, v16, v10
    v_and_b32 v31, v16, v11
    s_nop 1
    v_mfma_f32_16x16x32_bf16 v[20:23], v[28:31], v[96:99], v[20:23]
    v_mfma_f32_16x16x32_bf16 v[24:27], v[28:31], v[100:103], v[24:27]
    v_and_b32 v28, v17, v8
    v_and_b32 v29, v17, v9
    v_and_b32 v30, v17, v10
    v_and_b32 v31, v17, v11
    s_nop 1
    v_mfma_f32_16x16x32_bf16 v[20:23], v[28:31], v[104:107], v[20:23]
    v_mfma_f32_16x16x32_bf16 v[24:27], v[28:31], v[108:111], v[24:27]
    v_and_b32 v28, v18, v8
    v_and_b32 v29, v18, v9
    v_and_b32 v30, v18, v10
    v_and_b32 v31, v18, v11
    s_nop 1
    v_mfma_f32_16x16x32_bf16 v[20:23], v[28:31], v[112:115], v[20:23]
    v_mfma_f32_16x16x32_bf16 v[24:27], v[28:31], v[116:119], v[24:27]
    v_and_b32 v28, v19, v8
    v_and_b32 v29, v19, v9
    v_and_b32 v30, v19, v10
    v_and_b32 v31, v19, v11
    s_nop 1
    v_mfma_f32_16x16x32_bf16 v[20:23], v[28:31], v[120:123], v[20:23]
    v_mfma_f32_16x16x32_bf16 v[24:27], v[28:31], v[124:127], v[24:27]
    buffer_load_dwordx4 v[96:99], v13, s[8:11], s80 offen offset:0 nt
    buffer_load_dwordx4 v[100:103], v13, s[8:11], s80 offen offset:256 nt
    buffer_load_dwordx4 v[104:107], v13, s[8:11], s80 offen offset:512 nt
    buffer_load_dwordx4 v[108:111], v13, s[8:11], s80 offen offset:768 nt
    buffer_load_dwordx4 v[112:115], v13, s[8:11], s80 offen offset:1024 nt
    buffer_load_dwordx4 v[116:119], v13, s[8:11], s80 offen offset:1280 nt
    buffer_load_dwordx4 v[120:123], v13, s[8:11], s80 offen offset:1536 nt
    buffer_load_dwordx4 v[124:127], v13, s[8:11], s80 offen offset:1792 nt
    s_add_u32 s80, s80, 524288
    s_waitcnt lgkmcnt(0)
    v_mfma_f32_16x16x32_bf16 v[16:19], a[0:3], v[32:35], 0
    v_mfma_f32_16x16x32_bf16 v[16:19], a[4:7], v[36:39], v[16:19]
    v_mfma_f32_16x16x32_bf16 v[16:19], a[8:11], v[40:43], v[16:19]
    v_mfma_f32_16x16x32_bf16 v[16:19], a[12:15], v[44:47], v[16:19]
    v_mfma_f32_16x16x32_bf16 v[16:19], a[16:19], v[48:51], v[16:19]
    v_mfma_f32_16x16x32_bf16 v[16:19], a[20:23], v[52:55], v[16:19]
    v_mfma_f32_16x16x32_bf16 v[16:19], a[24:27], v[56:59], v[16:19]
    v_mfma_f32_16x16x32_bf16 v[16:19], a[28:31], v[60:63], v[16:19]
    s_nop 7
    v_cvt_pk_bf16_f32 v0, v16, v17
    v_cvt_pk_bf16_f32 v4, v18, v19
    v_lshlrev_b32 v16, 16, v0
    v_and_b32 v17, 0xffff0000, v0
    v_lshlrev_b32 v18, 16, v4
    v_and_b32 v19, 0xffff0000, v4
    v_max3_f32 v0, v16, v17, v18
    v_max_f32 v0, v0, v19
    v_mov_b32 v4, v0
    s_nop 1
    v_permlane16_swap_b32 v0, v4
    v_max_f32 v0, v0, v4
    v_mov_b32 v4, v0
    s_nop 1
    v_permlane32_swap_b32 v0, v4
    v_max_f32 v0, v0, v4
    v_mul_f32 v0, s64, v0
    v_ceil_f32 v0, v0
    v_max_f32 v0, v0, v14
    v_sub_f32 v4, v14, v0
    v_exp_f32 v4, v4
    v_mov_b32 v14, v0
    v_fma_f32 v16, v16, s64, -v0
    v_fma_f32 v17, v17, s64, -v0
    v_fma_f32 v18, v18, s64, -v0
    v_fma_f32 v19, v19, s64, -v0
    v_exp_f32 v16, v16
    v_exp_f32 v17, v17
    v_exp_f32 v18, v18
    v_exp_f32 v19, v19
    v_mul_f32_dpp v20, v4, v20 quad_perm:[0,0,2,2] row_mask:0xf bank_mask:0xf
    v_mul_f32_dpp v21, v4, v21 quad_perm:[1,1,3,3] row_mask:0xf bank_mask:0xf
    v_mul_f32_dpp v22, v4, v22 quad_perm:[0,0,2,2] row_mask:0xf bank_mask:0xf
    v_mul_f32_dpp v23, v4, v23 quad_perm:[1,1,3,3] row_mask:0xf bank_mask:0xf
    v_mul_f32_dpp v24, v4, v24 quad_perm:[0,0,2,2] row_mask:0xf bank_mask:0xf
    v_mul_f32_dpp v25, v4, v25 quad_perm:[1,1,3,3] row_mask:0xf bank_mask:0xf
    v_mul_f32_dpp v26, v4, v26 quad_perm:[0,0,2,2] row_mask:0xf bank_mask:0xf
    v_mul_f32_dpp v27, v4, v27 quad_perm:[1,1,3,3] row_mask:0xf bank_mask:0xf
    v_add_f32 v6, v16, v17
    v_add_f32 v7, v18, v19
    v_add_f32 v6, v6, v7
    v_fma_f32 v15, v15, v4, v6
    v_cvt_pk_bf16_f32 v16, v16, v16
    v_cvt_pk_bf16_f32 v17, v17, v17
    v_cvt_pk_bf16_f32 v18, v18, v18
    v_cvt_pk_bf16_f32 v19, v19, v19
    v_and_b32 v28, v16, v8
    v_and_b32 v29, v16, v9
    v_and_b32 v30, v16, v10
    v_and_b32 v31, v16, v11
    s_nop 1
    v_mfma_f32_16x16x32_bf16 v[20:23], v[28:31], a[32:35], v[20:23]
    v_mfma_f32_16x16x32_bf16 v[24:27], v[28:31], a[36:39], v[24:27]
    v_and_b32 v28, v17, v8
    v_and_b32 v29, v17, v9
    v_and_b32 v30, v17, v10
    v_and_b32 v31, v17, v11
    s_nop 1
    v_mfma_f32_16x16x32_bf16 v[20:23], v[28:31], a[40:43], v[20:23]
    v_mfma_f32_16x16x32_bf16 v[24:27], v[28:31], a[44:47], v[24:27]
    v_and_b32 v28, v18, v8
    v_and_b32 v29, v18, v9
    v_and_b32 v30, v18, v10
    v_and_b32 v31, v18, v11
    s_nop 1
    v_mfma_f32_16x16x32_bf16 v[20:23], v[28:31], a[48:51], v[20:23]
    v_mfma_f32_16x16x32_bf16 v[24:27], v[28:31], a[52:55], v[24:27]
    v_and_b32 v28, v19, v8
    v_and_b32 v29, v19, v9
    v_and_b32 v30, v19, v10
    v_and_b32 v31, v19, v11
    s_nop 1
    v_mfma_f32_16x16x32_bf16 v[20:23], v[28:31], a[56:59], v[20:23]
    v_mfma_f32_16x16x32_bf16 v[24:27], v[28:31], a[60:63], v[24:27]
    s_waitcnt lgkmcnt(0)
    v_mfma_f32_16x16x32_bf16 v[16:19], a[64:67], v[32:35], 0
    v_mfma_f32_16x16x32_bf16 v[16:19], a[68:71], v[36:39], v[16:19]
    v_mfma_f32_16x16x32_bf16 v[16:19], a[72:75], v[40:43], v[16:19]
    v_mfma_f32_16x16x32_bf16 v[16:19], a[76:79], v[44:47], v[16:19]
    v_mfma_f32_16x16x32_bf16 v[16:19], a[80:83], v[48:51], v[16:19]
    v_mfma_f32_16x16x32_bf16 v[16:19], a[84:87], v[52:55], v[16:19]
    v_mfma_f32_16x16x32_bf16 v[16:19], a[88:91], v[56:59], v[16:19]
    v_mfma_f32_16x16x32_bf16 v[16:19], a[92:95], v[60:63], v[16:19]
    s_nop 7
    v_cvt_pk_bf16_f32 v0, v16, v17
    v_cvt_pk_bf16_f32 v4, v18, v19
    v_lshlrev_b32 v16, 16, v0
    v_and_b32 v17, 0xffff0000, v0
    v_lshlrev_b32 v18, 16, v4
    v_and_b32 v19, 0xffff0000, v4
    v_max3_f32 v0, v16, v17, v18
    v_max_f32 v0, v0, v19
    v_mov_b32 v4, v0
    s_nop 1
    v_permlane16_swap_b32 v0, v4
    v_max_f32 v0, v0, v4
    v_mov_b32 v4, v0
    s_nop 1
    v_permlane32_swap_b32 v0, v4
    v_max_f32 v0, v0, v4
    v_mul_f32 v0, s64, v0
    v_ceil_f32 v0, v0
    v_max_f32 v0, v0, v14
    v_sub_f32 v4, v14, v0
    v_exp_f32 v4, v4
    v_mov_b32 v14, v0
    v_fma_f32 v16, v16, s64, -v0
    v_fma_f32 v17, v17, s64, -v0
    v_fma_f32 v18, v18, s64, -v0
    v_fma_f32 v19, v19, s64, -v0
    v_exp_f32 v16, v16
    v_exp_f32 v17, v17
    v_exp_f32 v18, v18
    v_exp_f32 v19, v19
    v_mul_f32_dpp v20, v4, v20 quad_perm:[0,0,2,2] row_mask:0xf bank_mask:0xf
    v_mul_f32_dpp v21, v4, v21 quad_perm:[1,1,3,3] row_mask:0xf bank_mask:0xf
    v_mul_f32_dpp v22, v4, v22 quad_perm:[0,0,2,2] row_mask:0xf bank_mask:0xf
    v_mul_f32_dpp v23, v4, v23 quad_perm:[1,1,3,3] row_mask:0xf bank_mask:0xf
    v_mul_f32_dpp v24, v4, v24 quad_perm:[0,0,2,2] row_mask:0xf bank_mask:0xf
    v_mul_f32_dpp v25, v4, v25 quad_perm:[1,1,3,3] row_mask:0xf bank_mask:0xf
    v_mul_f32_dpp v26, v4, v26 quad_perm:[0,0,2,2] row_mask:0xf bank_mask:0xf
    v_mul_f32_dpp v27, v4, v27 quad_perm:[1,1,3,3] row_mask:0xf bank_mask:0xf
    v_add_f32 v6, v16, v17
    v_add_f32 v7, v18, v19
    v_add_f32 v6, v6, v7
    v_fma_f32 v15, v15, v4, v6
    v_cvt_pk_bf16_f32 v16, v16, v16
    v_cvt_pk_bf16_f32 v17, v17, v17
    v_cvt_pk_bf16_f32 v18, v18, v18
    v_cvt_pk_bf16_f32 v19, v19, v19
    v_and_b32 v28, v16, v8
    v_and_b32 v29, v16, v9
    v_and_b32 v30, v16, v10
    v_and_b32 v31, v16, v11
    s_nop 1
    v_mfma_f32_16x16x32_bf16 v[20:23], v[28:31], a[96:99], v[20:23]
    v_mfma_f32_16x16x32_bf16 v[24:27], v[28:31], a[100:103], v[24:27]
    v_and_b32 v28, v17, v8
    v_and_b32 v29, v17, v9
    v_and_b32 v30, v17, v10
    v_and_b32 v31, v17, v11
    s_nop 1
    v_mfma_f32_16x16x32_bf16 v[20:23], v[28:31], a[104:107], v[20:23]
    v_mfma_f32_16x16x32_bf16 v[24:27], v[28:31], a[108:111], v[24:27]
    v_and_b32 v28, v18, v8
    v_and_b32 v29, v18, v9
    v_and_b32 v30, v18, v10
    v_and_b32 v31, v18, v11
    s_nop 1
    v_mfma_f32_16x16x32_bf16 v[20:23], v[28:31], a[112:115], v[20:23]
    v_mfma_f32_16x16x32_bf16 v[24:27], v[28:31], a[116:119], v[24:27]
    v_and_b32 v28, v19, v8
    v_and_b32 v29, v19, v9
    v_and_b32 v30, v19, v10
    v_and_b32 v31, v19, v11
    s_nop 1
    v_mfma_f32_16x16x32_bf16 v[20:23], v[28:31], a[120:123], v[20:23]
    v_mfma_f32_16x16x32_bf16 v[24:27], v[28:31], a[124:127], v[24:27]
    s_cmp_lg_u32 s63, 0
    s_cbranch_scc1 L_noref
    v_readlane_b32 s65, v14, 0
    v_readlane_b32 s66, v14, 1
    s_nop 1
    v_mov_b32 v4, s65
    v_mov_b32 v5, s66
    v_mov_b32 v6, 1
    s_mov_b64 exec, 1
    buffer_store_dwordx3 v[4:6], v3, s[12:15], s84 offen offset:512 sc1
    s_mov_b64 exec, -1
    s_nop 1
L_noref:
    s_mul_i32 s87, s60, 896
    s_add_u32 s87, s87, s84
    s_mov_b32 s100, 1
    s_atomic_add s100, s[58:59], s87 glc
    s_mov_b32 s81, 28
L_staticA:
    s_waitcnt vmcnt(8)
    v_mfma_f32_16x16x32_bf16 v[16:19], v[64:67], v[32:35], 0
    v_mfma_f32_16x16x32_bf16 v[16:19], v[68:71], v[36:39], v[16:19]
    v_mfma_f32_16x16x32_bf16 v[16:19], v[72:75], v[40:43], v[16:19]
    v_mfma_f32_16x16x32_bf16 v[16:19], v[76:79], v[44:47], v[16:19]
    v_mfma_f32_16x16x32_bf16 v[16:19], v[80:83], v[48:51], v[16:19]
    v_mfma_f32_16x16x32_bf16 v[16:19], v[84:87], v[52:55], v[16:19]
    v_mfma_f32_16x16x32_bf16 v[16:19], v[88:91], v[56:59], v[16:19]
    v_mfma_f32_16x16x32_bf16 v[16:19], v[92:95], v[60:63], v[16:19]
    buffer_load_dwordx4 v[64:67], v12, s[4:7], s80 offen offset:0 nt
    buffer_load_dwordx4 v[68:71], v12, s[4:7], s80 offen offset:64 nt
    buffer_load_dwordx4 v[72:75], v12, s[4:7], s80 offen offset:128 nt
    buffer_load_dwordx4 v[76:79], v12, s[4:7], s80 offen offset:192 nt
    buffer_load_dwordx4 v[80:83], v12, s[4:7], s80 offen offset:256 nt
    buffer_load_dwordx4 v[84:87], v12, s[4:7], s80 offen offset:320 nt
    buffer_load_dwordx4 v[88:91], v12, s[4:7], s80 offen offset:384 nt
    buffer_load_dwordx4 v[92:95], v12, s[4:7], s80 offen offset:448 nt
    v_cvt_pk_bf16_f32 v0, v16, v17
    v_cvt_pk_bf16_f32 v4, v18, v19
    v_lshlrev_b32 v16, 16, v0
    v_and_b32 v17, 0xffff0000, v0
    v_lshlrev_b32 v18, 16, v4
    v_and_b32 v19, 0xffff0000, v4
    v_max3_f32 v0, v16, v17, v18
    v_max_f32 v0, v0, v19
    v_mov_b32 v4, v0
    s_nop 1
    v_permlane16_swap_b32 v0, v4
    v_max_f32 v0, v0, v4
    v_mov_b32 v4, v0
    s_nop 1
    v_permlane32_swap_b32 v0, v4
    v_max_f32 v0, v0, v4
    v_mul_f32 v0, s64, v0
    v_ceil_f32 v0, v0
    v_max_f32 v0, v0, v14
    v_sub_f32 v4, v14, v0
    v_exp_f32 v4, v4
    v_mov_b32 v14, v0
    v_fma_f32 v16, v16, s64, -v0
    v_fma_f32 v17, v17, s64, -v0
    v_fma_f32 v18, v18, s64, -v0
    v_fma_f32 v19, v19, s64, -v0
    v_exp_f32 v16, v16
    v_exp_f32 v17, v17
    v_exp_f32 v18, v18
    v_exp_f32 v19, v19
    v_mul_f32_dpp v20, v4, v20 quad_perm:[0,0,2,2] row_mask:0xf bank_mask:0xf
    v_mul_f32_dpp v21, v4, v21 quad_perm:[1,1,3,3] row_mask:0xf bank_mask:0xf
    v_mul_f32_dpp v22, v4, v22 quad_perm:[0,0,2,2] row_mask:0xf bank_mask:0xf
    v_mul_f32_dpp v23, v4, v23 quad_perm:[1,1,3,3] row_mask:0xf bank_mask:0xf
    v_mul_f32_dpp v24, v4, v24 quad_perm:[0,0,2,2] row_mask:0xf bank_mask:0xf
    v_mul_f32_dpp v25, v4, v25 quad_perm:[1,1,3,3] row_mask:0xf bank_mask:0xf
    v_mul_f32_dpp v26, v4, v26 quad_perm:[0,0,2,2] row_mask:0xf bank_mask:0xf
    v_mul_f32_dpp v27, v4, v27 quad_perm:[1,1,3,3] row_mask:0xf bank_mask:0xf
    v_add_f32 v6, v16, v17
    v_add_f32 v7, v18, v19
    v_add_f32 v6, v6, v7
    v_fma_f32 v15, v15, v4, v6
    v_cvt_pk_bf16_f32 v16, v16, v16
    v_cvt_pk_bf16_f32 v17, v17, v17
    v_cvt_pk_bf16_f32 v18, v18, v18
    v_cvt_pk_bf16_f32 v19, v19, v19
    s_waitcnt vmcnt(8)
    v_and_b32 v28, v16, v8
    v_and_b32 v29, v16, v9
    v_and_b32 v30, v16, v10
    v_and_b32 v31, v16, v11
    s_nop 1
    v_mfma_f32_16x16x32_bf16 v[20:23], v[28:31], v[96:99], v[20:23]
    v_mfma_f32_16x16x32_bf16 v[24:27], v[28:31], v[100:103], v[24:27]
    v_and_b32 v28, v17, v8
    v_and_b32 v29, v17, v9
    v_and_b32 v30, v17, v10
    v_and_b32 v31, v17, v11
    s_nop 1
    v_mfma_f32_16x16x32_bf16 v[20:23], v[28:31], v[104:107], v[20:23]
    v_mfma_f32_16x16x32_bf16 v[24:27], v[28:31], v[108:111], v[24:27]
    v_and_b32 v28, v18, v8
    v_and_b32 v29, v18, v9
    v_and_b32 v30, v18, v10
    v_and_b32 v31, v18, v11
    s_nop 1
    v_mfma_f32_16x16x32_bf16 v[20:23], v[28:31], v[112:115], v[20:23]
    v_mfma_f32_16x16x32_bf16 v[24:27], v[28:31], v[116:119], v[24:27]
    v_and_b32 v28, v19, v8
    v_and_b32 v29, v19, v9
    v_and_b32 v30, v19, v10
    v_and_b32 v31, v19, v11
    s_nop 1
    v_mfma_f32_16x16x32_bf16 v[20:23], v[28:31], v[120:123], v[20:23]
    v_mfma_f32_16x16x32_bf16 v[24:27], v[28:31], v[124:127], v[24:27]
    buffer_load_dwordx4 v[96:99], v13, s[8:11], s80 offen offset:0 nt
    buffer_load_dwordx4 v[100:103], v13, s[8:11], s80 offen offset:256 nt
    buffer_load_dwordx4 v[104:107], v13, s[8:11], s80 offen offset:512 nt
    buffer_load_dwordx4 v[108:111], v13, s[8:11], s80 offen offset:768 nt
    buffer_load_dwordx4 v[112:115], v13, s[8:11], s80 offen offset:1024 nt
    buffer_load_dwordx4 v[116:119], v13, s[8:11], s80 offen offset:1280 nt
    buffer_load_dwordx4 v[120:123], v13, s[8:11], s80 offen offset:1536 nt
    buffer_load_dwordx4 v[124:127], v13, s[8:11], s80 offen offset:1792 nt
    s_add_u32 s80, s80, 524288
    s_sub_u32 s81, s81, 1
    s_cmp_lg_u32 s81, 0
    s_cbranch_scc1 L_staticA
    s_cmp_ge_u32 s63, 46
    s_cbranch_scc1 L_dyn0
    s_mov_b32 s81, 16
L_staticB:
    s_waitcnt vmcnt(8)
    v_mfma_f32_16x16x32_bf16 v[16:19], v[64:67], v[32:35], 0
    v_mfma_f32_16x16x32_bf16 v[16:19], v[68:71], v[36:39], v[16:19]
    v_mfma_f32_16x16x32_bf16 v[16:19], v[72:75], v[40:43], v[16:19]
    v_mfma_f32_16x16x32_bf16 v[16:19], v[76:79], v[44:47], v[16:19]
    v_mfma_f32_16x16x32_bf16 v[16:19], v[80:83], v[48:51], v[16:19]
    v_mfma_f32_16x16x32_bf16 v[16:19], v[84:87], v[52:55], v[16:19]
    v_mfma_f32_16x16x32_bf16 v[16:19], v[88:91], v[56:59], v[16:19]
    v_mfma_f32_16x16x32_bf16 v[16:19], v[92:95], v[60:63], v[16:19]
    buffer_load_dwordx4 v[64:67], v12, s[4:7], s80 offen offset:0 nt
    buffer_load_dwordx4 v[68:71], v12, s[4:7], s80 offen offset:64 nt
    buffer_load_dwordx4 v[72:75], v12, s[4:7], s80 offen offset:128 nt
    buffer_load_dwordx4 v[76:79], v12, s[4:7], s80 offen offset:192 nt
    buffer_load_dwordx4 v[80:83], v12, s[4:7], s80 offen offset:256 nt
    buffer_load_dwordx4 v[84:87], v12, s[4:7], s80 offen offset:320 nt
    buffer_load_dwordx4 v[88:91], v12, s[4:7], s80 offen offset:384 nt
    buffer_load_dwordx4 v[92:95], v12, s[4:7], s80 offen offset:448 nt
    v_cvt_pk_bf16_f32 v0, v16, v17
    v_cvt_pk_bf16_f32 v4, v18, v19
    v_lshlrev_b32 v16, 16, v0
    v_and_b32 v17, 0xffff0000, v0
    v_lshlrev_b32 v18, 16, v4
    v_and_b32 v19, 0xffff0000, v4
    v_max3_f32 v0, v16, v17, v18
    v_max_f32 v0, v0, v19
    v_mov_b32 v4, v0
    s_nop 1
    v_permlane16_swap_b32 v0, v4
    v_max_f32 v0, v0, v4
    v_mov_b32 v4, v0
    s_nop 1
    v_permlane32_swap_b32 v0, v4
    v_max_f32 v0, v0, v4
    v_mul_f32 v0, s64, v0
    v_ceil_f32 v0, v0
    v_max_f32 v0, v0, v14
    v_sub_f32 v4, v14, v0
    v_exp_f32 v4, v4
    v_mov_b32 v14, v0
    v_fma_f32 v16, v16, s64, -v0
    v_fma_f32 v17, v17, s64, -v0
    v_fma_f32 v18, v18, s64, -v0
    v_fma_f32 v19, v19, s64, -v0
    v_exp_f32 v16, v16
    v_exp_f32 v17, v17
    v_exp_f32 v18, v18
    v_exp_f32 v19, v19
    v_mul_f32_dpp v20, v4, v20 quad_perm:[0,0,2,2] row_mask:0xf bank_mask:0xf
    v_mul_f32_dpp v21, v4, v21 quad_perm:[1,1,3,3] row_mask:0xf bank_mask:0xf
    v_mul_f32_dpp v22, v4, v22 quad_perm:[0,0,2,2] row_mask:0xf bank_mask:0xf
    v_mul_f32_dpp v23, v4, v23 quad_perm:[1,1,3,3] row_mask:0xf bank_mask:0xf
    v_mul_f32_dpp v24, v4, v24 quad_perm:[0,0,2,2] row_mask:0xf bank_mask:0xf
    v_mul_f32_dpp v25, v4, v25 quad_perm:[1,1,3,3] row_mask:0xf bank_mask:0xf
    v_mul_f32_dpp v26, v4, v26 quad_perm:[0,0,2,2] row_mask:0xf bank_mask:0xf
    v_mul_f32_dpp v27, v4, v27 quad_perm:[1,1,3,3] row_mask:0xf bank_mask:0xf
    v_add_f32 v6, v16, v17
    v_add_f32 v7, v18, v19
    v_add_f32 v6, v6, v7
    v_fma_f32 v15, v15, v4, v6
    v_cvt_pk_bf16_f32 v16, v16, v16
    v_cvt_pk_bf16_f32 v17, v17, v17
    v_cvt_pk_bf16_f32 v18, v18, v18
    v_cvt_pk_bf16_f32 v19, v19, v19
    s_waitcnt vmcnt(8)
    v_and_b32 v28, v16, v8
    v_and_b32 v29, v16, v9
    v_and_b32 v30, v16, v10
    v_and_b32 v31, v16, v11
    s_nop 1
    v_mfma_f32_16x16x32_bf16 v[20:23], v[28:31], v[96:99], v[20:23]
    v_mfma_f32_16x16x32_bf16 v[24:27], v[28:31], v[100:103], v[24:27]
    v_and_b32 v28, v17, v8
    v_and_b32 v29, v17, v9
    v_and_b32 v30, v17, v10
    v_and_b32 v31, v17, v11
    s_nop 1
    v_mfma_f32_16x16x32_bf16 v[20:23], v[28:31], v[104:107], v[20:23]
    v_mfma_f32_16x16x32_bf16 v[24:27], v[28:31], v[108:111], v[24:27]
    v_and_b32 v28, v18, v8
    v_and_b32 v29, v18, v9
    v_and_b32 v30, v18, v10
    v_and_b32 v31, v18, v11
    s_nop 1
    v_mfma_f32_16x16x32_bf16 v[20:23], v[28:31], v[112:115], v[20:23]
    v_mfma_f32_16x16x32_bf16 v[24:27], v[28:31], v[116:119], v[24:27]
    v_and_b32 v28, v19, v8
    v_and_b32 v29, v19, v9
    v_and_b32 v30, v19, v10
    v_and_b32 v31, v19, v11
    s_nop 1
    v_mfma_f32_16x16x32_bf16 v[20:23], v[28:31], v[120:123], v[20:23]
    v_mfma_f32_16x16x32_bf16 v[24:27], v[28:31], v[124:127], v[24:27]
    buffer_load_dwordx4 v[96:99], v13, s[8:11], s80 offen offset:0 nt
    buffer_load_dwordx4 v[100:103], v13, s[8:11], s80 offen offset:256 nt
    buffer_load_dwordx4 v[104:107], v13, s[8:11], s80 offen offset:512 nt
    buffer_load_dwordx4 v[108:111], v13, s[8:11], s80 offen offset:768 nt
    buffer_load_dwordx4 v[112:115], v13, s[8:11], s80 offen offset:1024 nt
    buffer_load_dwordx4 v[116:119], v13, s[8:11], s80 offen offset:1280 nt
    buffer_load_dwordx4 v[120:123], v13, s[8:11], s80 offen offset:1536 nt
    buffer_load_dwordx4 v[124:127], v13, s[8:11], s80 offen offset:1792 nt
    s_add_u32 s80, s80, 376832
    s_sub_u32 s81, s81, 1
    s_cmp_lg_u32 s81, 0
    s_cbranch_scc1 L_staticB
L_dyn0:
L_dyn:
    s_waitcnt vmcnt(8)
    v_mfma_f32_16x16x32_bf16 v[16:19], v[64:67], v[32:35], 0
    v_mfma_f32_16x16x32_bf16 v[16:19], v[68:71], v[36:39], v[16:19]
    v_mfma_f32_16x16x32_bf16 v[16:19], v[72:75], v[40:43], v[16:19]
    v_mfma_f32_16x16x32_bf16 v[16:19], v[76:79], v[44:47], v[16:19]
    v_mfma_f32_16x16x32_bf16 v[16:19], v[80:83], v[48:51], v[16:19]
    v_mfma_f32_16x16x32_bf16 v[16:19], v[84:87], v[52:55], v[16:19]
    v_mfma_f32_16x16x32_bf16 v[16:19], v[88:91], v[56:59], v[16:19]
    v_mfma_f32_16x16x32_bf16 v[16:19], v[92:95], v[60:63], v[16:19]
    s_waitcnt lgkmcnt(0)
    s_cmp_ge_u32 s100, 272
    s_cbranch_scc1 L_last
    s_lshl_b32 s80, s100, 1
    s_add_u32 s80, s80, s60
    s_add_u32 s80, s80, 3552
    s_lshl_b32 s80, s80, 13
    s_mov_b32 s100, 1
    s_atomic_add s100, s[58:59], s87 glc
    buffer_load_dwordx4 v[64:67], v12, s[4:7], s80 offen offset:0 nt
    buffer_load_dwordx4 v[68:71], v12, s[4:7], s80 offen offset:64 nt
    buffer_load_dwordx4 v[72:75], v12, s[4:7], s80 offen offset:128 nt
    buffer_load_dwordx4 v[76:79], v12, s[4:7], s80 offen offset:192 nt
    buffer_load_dwordx4 v[80:83], v12, s[4:7], s80 offen offset:256 nt
    buffer_load_dwordx4 v[84:87], v12, s[4:7], s80 offen offset:320 nt
    buffer_load_dwordx4 v[88:91], v12, s[4:7], s80 offen offset:384 nt
    buffer_load_dwordx4 v[92:95], v12, s[4:7], s80 offen offset:448 nt
    v_cvt_pk_bf16_f32 v0, v16, v17
    v_cvt_pk_bf16_f32 v4, v18, v19
    v_lshlrev_b32 v16, 16, v0
    v_and_b32 v17, 0xffff0000, v0
    v_lshlrev_b32 v18, 16, v4
    v_and_b32 v19, 0xffff0000, v4
    v_max3_f32 v0, v16, v17, v18
    v_max_f32 v0, v0, v19
    v_mov_b32 v4, v0
    s_nop 1
    v_permlane16_swap_b32 v0, v4
    v_max_f32 v0, v0, v4
    v_mov_b32 v4, v0
    s_nop 1
    v_permlane32_swap_b32 v0, v4
    v_max_f32 v0, v0, v4
    v_mul_f32 v0, s64, v0
    v_ceil_f32 v0, v0
    v_max_f32 v0, v0, v14
    v_sub_f32 v4, v14, v0
    v_exp_f32 v4, v4
    v_mov_b32 v14, v0
    v_fma_f32 v16, v16, s64, -v0
    v_fma_f32 v17, v17, s64, -v0
    v_fma_f32 v18, v18, s64, -v0
    v_fma_f32 v19, v19, s64, -v0
    v_exp_f32 v16, v16
    v_exp_f32 v17, v17
    v_exp_f32 v18, v18
    v_exp_f32 v19, v19
    v_mul_f32_dpp v20, v4, v20 quad_perm:[0,0,2,2] row_mask:0xf bank_mask:0xf
    v_mul_f32_dpp v21, v4, v21 quad_perm:[1,1,3,3] row_mask:0xf bank_mask:0xf
    v_mul_f32_dpp v22, v4, v22 quad_perm:[0,0,2,2] row_mask:0xf bank_mask:0xf
    v_mul_f32_dpp v23, v4, v23 quad_perm:[1,1,3,3] row_mask:0xf bank_mask:0xf
    v_mul_f32_dpp v24, v4, v24 quad_perm:[0,0,2,2] row_mask:0xf bank_mask:0xf
    v_mul_f32_dpp v25, v4, v25 quad_perm:[1,1,3,3] row_mask:0xf bank_mask:0xf
    v_mul_f32_dpp v26, v4, v26 quad_perm:[0,0,2,2] row_mask:0xf bank_mask:0xf
    v_mul_f32_dpp v27, v4, v27 quad_perm:[1,1,3,3] row_mask:0xf bank_mask:0xf
    v_add_f32 v6, v16, v17
    v_add_f32 v7, v18, v19
    v_add_f32 v6, v6, v7
    v_fma_f32 v15, v15, v4, v6
    v_cvt_pk_bf16_f32 v16, v16, v16
    v_cvt_pk_bf16_f32 v17, v17, v17
    v_cvt_pk_bf16_f32 v18, v18, v18
    v_cvt_pk_bf16_f32 v19, v19, v19
    s_waitcnt vmcnt(8)
    v_and_b32 v28, v16, v8
    v_and_b32 v29, v16, v9
    v_and_b32 v30, v16, v10
    v_and_b32 v31, v16, v11
    s_nop 1
    v_mfma_f32_16x16x32_bf16 v[20:23], v[28:31], v[96:99], v[20:23]
    v_mfma_f32_16x16x32_bf16 v[24:27], v[28:31], v[100:103], v[24:27]
    v_and_b32 v28, v17, v8
    v_and_b32 v29, v17, v9
    v_and_b32 v30, v17, v10
    v_and_b32 v31, v17, v11
    s_nop 1
    v_mfma_f32_16x16x32_bf16 v[20:23], v[28:31], v[104:107], v[20:23]
    v_mfma_f32_16x16x32_bf16 v[24:27], v[28:31], v[108:111], v[24:27]
    v_and_b32 v28, v18, v8
    v_and_b32 v29, v18, v9
    v_and_b32 v30, v18, v10
    v_and_b32 v31, v18, v11
    s_nop 1
    v_mfma_f32_16x16x32_bf16 v[20:23], v[28:31], v[112:115], v[20:23]
    v_mfma_f32_16x16x32_bf16 v[24:27], v[28:31], v[116:119], v[24:27]
    v_and_b32 v28, v19, v8
    v_and_b32 v29, v19, v9
    v_and_b32 v30, v19, v10
    v_and_b32 v31, v19, v11
    s_nop 1
    v_mfma_f32_16x16x32_bf16 v[20:23], v[28:31], v[120:123], v[20:23]
    v_mfma_f32_16x16x32_bf16 v[24:27], v[28:31], v[124:127], v[24:27]
    buffer_load_dwordx4 v[96:99], v13, s[8:11], s80 offen offset:0 nt
    buffer_load_dwordx4 v[100:103], v13, s[8:11], s80 offen offset:256 nt
    buffer_load_dwordx4 v[104:107], v13, s[8:11], s80 offen offset:512 nt
    buffer_load_dwordx4 v[108:111], v13, s[8:11], s80 offen offset:768 nt
    buffer_load_dwordx4 v[112:115], v13, s[8:11], s80 offen offset:1024 nt
    buffer_load_dwordx4 v[116:119], v13, s[8:11], s80 offen offset:1280 nt
    buffer_load_dwordx4 v[120:123], v13, s[8:11], s80 offen offset:1536 nt
    buffer_load_dwordx4 v[124:127], v13, s[8:11], s80 offen offset:1792 nt
    s_branch L_dyn
L_last:
    s_nop 7
    v_cvt_pk_bf16_f32 v0, v16, v17
    v_cvt_pk_bf16_f32 v4, v18, v19
    v_lshlrev_b32 v16, 16, v0
    v_and_b32 v17, 0xffff0000, v0
    v_lshlrev_b32 v18, 16, v4
    v_and_b32 v19, 0xffff0000, v4
    v_max3_f32 v0, v16, v17, v18
    v_max_f32 v0, v0, v19
    v_mov_b32 v4, v0
    s_nop 1
    v_permlane16_swap_b32 v0, v4
    v_max_f32 v0, v0, v4
    v_mov_b32 v4, v0
    s_nop 1
    v_permlane32_swap_b32 v0, v4
    v_max_f32 v0, v0, v4
    v_mul_f32 v0, s64, v0
    v_ceil_f32 v0, v0
    v_max_f32 v0, v0, v14
    v_sub_f32 v4, v14, v0
    v_exp_f32 v4, v4
    v_mov_b32 v14, v0
    v_fma_f32 v16, v16, s64, -v0
    v_fma_f32 v17, v17, s64, -v0
    v_fma_f32 v18, v18, s64, -v0
    v_fma_f32 v19, v19, s64, -v0
    v_exp_f32 v16, v16
    v_exp_f32 v17, v17
    v_exp_f32 v18, v18
    v_exp_f32 v19, v19
    v_mul_f32_dpp v20, v4, v20 quad_perm:[0,0,2,2] row_mask:0xf bank_mask:0xf
    v_mul_f32_dpp v21, v4, v21 quad_perm:[1,1,3,3] row_mask:0xf bank_mask:0xf
    v_mul_f32_dpp v22, v4, v22 quad_perm:[0,0,2,2] row_mask:0xf bank_mask:0xf
    v_mul_f32_dpp v23, v4, v23 quad_perm:[1,1,3,3] row_mask:0xf bank_mask:0xf
    v_mul_f32_dpp v24, v4, v24 quad_perm:[0,0,2,2] row_mask:0xf bank_mask:0xf
    v_mul_f32_dpp v25, v4, v25 quad_perm:[1,1,3,3] row_mask:0xf bank_mask:0xf
    v_mul_f32_dpp v26, v4, v26 quad_perm:[0,0,2,2] row_mask:0xf bank_mask:0xf
    v_mul_f32_dpp v27, v4, v27 quad_perm:[1,1,3,3] row_mask:0xf bank_mask:0xf
    v_add_f32 v6, v16, v17
    v_add_f32 v7, v18, v19
    v_add_f32 v6, v6, v7
    v_fma_f32 v15, v15, v4, v6
    v_cvt_pk_bf16_f32 v16, v16, v16
    v_cvt_pk_bf16_f32 v17, v17, v17
    v_cvt_pk_bf16_f32 v18, v18, v18
    v_cvt_pk_bf16_f32 v19, v19, v19
    s_waitcnt vmcnt(0)
    v_and_b32 v28, v16, v8
    v_and_b32 v29, v16, v9
    v_and_b32 v30, v16, v10
    v_and_b32 v31, v16, v11
    s_nop 1
    v_mfma_f32_16x16x32_bf16 v[20:23], v[28:31], v[96:99], v[20:23]
    v_mfma_f32_16x16x32_bf16 v[24:27], v[28:31], v[100:103], v[24:27]
    v_and_b32 v28, v17, v8
    v_and_b32 v29, v17, v9
    v_and_b32 v30, v17, v10
    v_and_b32 v31, v17, v11
    s_nop 1
    v_mfma_f32_16x16x32_bf16 v[20:23], v[28:31], v[104:107], v[20:23]
    v_mfma_f32_16x16x32_bf16 v[24:27], v[28:31], v[108:111], v[24:27]
    v_and_b32 v28, v18, v8
    v_and_b32 v29, v18, v9
    v_and_b32 v30, v18, v10
    v_and_b32 v31, v18, v11
    s_nop 1
    v_mfma_f32_16x16x32_bf16 v[20:23], v[28:31], v[112:115], v[20:23]
    v_mfma_f32_16x16x32_bf16 v[24:27], v[28:31], v[116:119], v[24:27]
    v_and_b32 v28, v19, v8
    v_and_b32 v29, v19, v9
    v_and_b32 v30, v19, v10
    v_and_b32 v31, v19, v11
    s_nop 1
    v_mfma_f32_16x16x32_bf16 v[20:23], v[28:31], v[120:123], v[20:23]
    v_mfma_f32_16x16x32_bf16 v[24:27], v[28:31], v[124:127], v[24:27]
    v_mov_b32 v4, v15
    s_nop 1
    v_permlane16_swap_b32 v15, v4
    v_add_f32 v15, v15, v4
    v_mov_b32 v4, v15
    s_nop 1
    v_permlane32_swap_b32 v15, v4
    v_add_f32 v15, v15, v4
    v_and_b32 v4, 15, v1
    v_lshlrev_b32 v4, 5, v4
    v_lshrrev_b32 v5, 4, v1
    v_lshl_add_u32 v4, v5, 3, v4
    s_lshl_b32 s65, s60, 11
    v_add_u32 v4, s65, v4
    v_add_u32 v5, 1024, v4
    s_nop 4
    v_add_u32 v6, 1024, v4
    ds_write2_b32 v6, v20, v22 offset0:0 offset1:1
    v_add_u32 v6, 1024, v5
    ds_write2_b32 v6, v21, v23 offset0:0 offset1:1
    v_add_u32 v6, 1536, v4
    ds_write2_b32 v6, v24, v26 offset0:0 offset1:1
    v_add_u32 v6, 1536, v5
    ds_write2_b32 v6, v25, v27 offset0:0 offset1:1
    v_lshlrev_b32 v4, 2, v1
    s_lshl_b32 s65, s60, 4
    v_add_u32 v4, s65, v4
    s_mov_b64 exec, 3
    ds_write_b32 v4, v14 offset:5120
    ds_write_b32 v4, v15 offset:5128
    s_mov_b64 exec, -1
    s_waitcnt lgkmcnt(0)
    s_barrier
    s_sub_u32 s65, s60, 0
    s_lshl_b32 s65, s65, 2
    v_mov_b32 v4, s65
    ds_read_b32 v16, v4 offset:5120
    ds_read_b32 v17, v4 offset:5128
    ds_read_b32 v18, v4 offset:5136
    ds_read_b32 v19, v4 offset:5144
    ds_read_b32 v25, v4 offset:5152
    s_lshl_b32 s65, s60, 10
    v_lshlrev_b32 v5, 2, v1
    v_add_u32 v6, s65, v5
    ds_read_b32 v32, v6 offset:1024
    ds_read_b32 v36, v6 offset:3072
    ds_read_b32 v33, v6 offset:1280
    ds_read_b32 v37, v6 offset:3328
    ds_read_b32 v34, v6 offset:1536
    ds_read_b32 v38, v6 offset:3584
    ds_read_b32 v35, v6 offset:1792
    ds_read_b32 v39, v6 offset:3840
    s_waitcnt lgkmcnt(8)
    v_max_f32 v22, v16, v18
    v_sub_f32 v20, v16, v22
    v_sub_f32 v21, v18, v22
    v_sub_f32 v24, v22, v25
    v_exp_f32 v20, v20
    v_exp_f32 v21, v21
    v_exp_f32 v26, v24
    s_nop 0
    v_mul_f32 v23, v20, v17
    v_fma_f32 v23, v21, v19, v23
    v_mul_f32 v20, v20, v26
    v_mul_f32 v21, v21, v26
    v_mul_f32 v23, v23, v26
    s_waitcnt lgkmcnt(0)
    s_lshl_b32 s66, s61, 11
    s_add_u32 s66, s66, s65
    s_add_u32 s66, s66, 65536
    v_mul_f32 v32, v20, v32
    v_fma_f32 v32, v21, v36, v32
    buffer_atomic_add_f32 v32, v5, s[12:15], s66 offen offset:0
    v_mul_f32 v33, v20, v33
    v_fma_f32 v33, v21, v37, v33
    buffer_atomic_add_f32 v33, v5, s[12:15], s66 offen offset:256
    v_mul_f32 v34, v20, v34
    v_fma_f32 v34, v21, v38, v34
    buffer_atomic_add_f32 v34, v5, s[12:15], s66 offen offset:512
    v_mul_f32 v35, v20, v35
    v_fma_f32 v35, v21, v39, v35
    buffer_atomic_add_f32 v35, v5, s[12:15], s66 offen offset:768
    s_lshl_b32 s65, s60, 2
    s_add_u32 s65, s65, s84
    v_mov_b32 v3, 0
    v_mov_b32 v27, 0x42800000
    v_cmp_ngt_f32 vcc, v27, v24
    s_mov_b64 exec, 1
    buffer_atomic_add_f32 v23, v3, s[12:15], s65 offen offset:256
    s_and_b64 vcc, vcc, exec
    s_cbranch_vccz L_safe
    v_mov_b32 v27, 1
    buffer_atomic_or v27, v3, s[16:19], 0 offen offset:32
L_safe:
    s_mov_b64 exec, -1
    s_waitcnt vmcnt(0)
    s_barrier
    s_cmp_lg_u32 s60, 0
    s_cbranch_scc1 L_done
    v_mov_b32 v27, 1
    s_mov_b64 exec, 1
    buffer_atomic_add v27, v3, s[12:15], s84 offen offset:128 sc0
    s_waitcnt vmcnt(0)
    v_readfirstlane_b32 s65, v27
    s_cmp_lg_u32 s65, 31
    s_cbranch_scc1 L_arr_done
    s_mov_b64 exec, 0xff
    v_lshlrev_b32 v5, 10, v1
    v_mov_b32 v27, 1
    s_lshl_b32 s65, s61, 2
    s_add_u32 s65, s65, 81920
    buffer_store_dword v27, v5, s[12:15], s65 offen offset:384 sc1
L_arr_done:
    s_branch L_done
L_helper:
    v_mov_b32 v3, 0
    v_and_b32 v12, 15, v1
    v_lshrrev_b32 v13, 4, v1
    s_mov_b32 s20, s32
    s_mov_b32 s21, s33
    s_mov_b32 s22, 896
    s_mov_b32 s23, 0x20000
    s_cmp_eq_u32 s60, 2
    s_cbranch_scc1 L_h2
    s_cmp_lt_u32 s62, 16
    s_cbranch_scc1 L_qprod
    s_barrier
    s_branch L_h3_b1
L_qprod:
    s_and_b32 s65, s62, 3
    s_lshr_b32 s66, s62, 2
    s_mov_b32 s24, s38
    s_mov_b32 s25, s39
    s_mov_b32 s26, 3670016
    s_mov_b32 s27, 0x20000
    v_mul_u32_u24 v4, 56, v13
    s_mul_i32 s67, s66, 224
    s_mov_b32 s68, 229376
    v_mul_lo_u32 v5, v13, s68
    v_lshl_add_u32 v5, v12, 4, v5
    s_mul_i32 s68, s66, 917504
    s_lshl_b32 s69, s61, 10
    s_add_u32 s68, s68, s69
    s_lshl_b32 s69, s65, 8
    s_add_u32 s68, s68, s69
    buffer_load_dwordx2 v[32:33], v4, s[20:23], s67 offen offset:0
    buffer_load_dwordx2 v[34:35], v4, s[20:23], s67 offen offset:8
    buffer_load_dwordx2 v[36:37], v4, s[20:23], s67 offen offset:16
    buffer_load_dwordx2 v[38:39], v4, s[20:23], s67 offen offset:24
    buffer_load_dwordx2 v[40:41], v4, s[20:23], s67 offen offset:32
    buffer_load_dwordx2 v[42:43], v4, s[20:23], s67 offen offset:40
    buffer_load_dwordx2 v[44:45], v4, s[20:23], s67 offen offset:48
    buffer_load_dwordx4 v[64:67], v5, s[24:27], s68 offen nt
    s_add_u32 s68, s68, 8192
    buffer_load_dwordx4 v[68:71], v5, s[24:27], s68 offen nt
    s_add_u32 s68, s68, 8192
    buffer_load_dwordx4 v[72:75], v5, s[24:27], s68 offen nt
    s_add_u32 s68, s68, 8192
    buffer_load_dwordx4 v[76:79], v5, s[24:27], s68 offen nt
    s_add_u32 s68, s68, 8192
    buffer_load_dwordx4 v[80:83], v5, s[24:27], s68 offen nt
    s_add_u32 s68, s68, 8192
    buffer_load_dwordx4 v[84:87], v5, s[24:27], s68 offen nt
    s_add_u32 s68, s68, 8192
    buffer_load_dwordx4 v[88:91], v5, s[24:27], s68 offen nt
    s_add_u32 s68, s68, 8192
    buffer_load_dwordx4 v[92:95], v5, s[24:27], s68 offen nt
    s_add_u32 s68, s68, 8192
    buffer_load_dwordx4 v[96:99], v5, s[24:27], s68 offen nt
    s_add_u32 s68, s68, 8192
    buffer_load_dwordx4 v[100:103], v5, s[24:27], s68 offen nt
    s_add_u32 s68, s68, 8192
    buffer_load_dwordx4 v[104:107], v5, s[24:27], s68 offen nt
    s_add_u32 s68, s68, 8192
    buffer_load_dwordx4 v[108:111], v5, s[24:27], s68 offen nt
    s_add_u32 s68, s68, 8192
    buffer_load_dwordx4 v[112:115], v5, s[24:27], s68 offen nt
    s_add_u32 s68, s68, 8192
    buffer_load_dwordx4 v[116:119], v5, s[24:27], s68 offen nt
    s_add_u32 s68, s68, 8192
    buffer_load_dwordx4 v[120:123], v5, s[24:27], s68 offen nt
    s_add_u32 s68, s68, 8192
    buffer_load_dwordx4 v[124:127], v5, s[24:27], s68 offen nt
    s_add_u32 s68, s68, 8192
    buffer_load_dwordx4 v[128:131], v5, s[24:27], s68 offen nt
    s_add_u32 s68, s68, 8192
    buffer_load_dwordx4 v[132:135], v5, s[24:27], s68 offen nt
    s_add_u32 s68, s68, 8192
    buffer_load_dwordx4 v[136:139], v5, s[24:27], s68 offen nt
    s_add_u32 s68, s68, 8192
    buffer_load_dwordx4 v[140:143], v5, s[24:27], s68 offen nt
    s_add_u32 s68, s68, 8192
    buffer_load_dwordx4 v[144:147], v5, s[24:27], s68 offen nt
    s_add_u32 s68, s68, 8192
    buffer_load_dwordx4 v[148:151], v5, s[24:27], s68 offen nt
    s_add_u32 s68, s68, 8192
    buffer_load_dwordx4 v[152:155], v5, s[24:27], s68 offen nt
    s_add_u32 s68, s68, 8192
    buffer_load_dwordx4 v[156:159], v5, s[24:27], s68 offen nt
    s_add_u32 s68, s68, 8192
    buffer_load_dwordx4 v[160:163], v5, s[24:27], s68 offen nt
    s_add_u32 s68, s68, 8192
    buffer_load_dwordx4 v[164:167], v5, s[24:27], s68 offen nt
    s_add_u32 s68, s68, 8192
    buffer_load_dwordx4 v[168:171], v5, s[24:27], s68 offen nt
    s_add_u32 s68, s68, 8192
    buffer_load_dwordx4 v[172:175], v5, s[24:27], s68 offen nt
    s_add_u32 s68, s68, 8192
    s_barrier
    s_cmp_lg_u32 s66, 0
    s_cbranch_scc1 L_nozero
    v_mov_b32 v20, 0
    v_mov_b32 v21, 0
    v_mov_b32 v22, 0
    v_mov_b32 v23, 0
    v_lshlrev_b32 v6, 4, v1
    s_lshl_b32 s68, s61, 11
    s_lshl_b32 s69, s65, 9
    s_add_u32 s68, s68, s69
    s_add_u32 s68, s68, 65536
    s_mov_b32 exec_hi, 0
    buffer_store_dwordx4 v[20:23], v6, s[12:15], s68 offen sc1
    s_mov_b64 exec, -1
    s_cmp_lg_u32 s65, 0
    s_cbranch_scc1 L_nozero
    buffer_store_dwordx4 v[20:23], v6, s[12:15], s84 offen sc1
L_nozero:
    s_waitcnt vmcnt(27)
    v_perm_b32 v16, v32, v32, s82
    v_and_b32 v28, v16, v8
    v_and_b32 v29, v16, v9
    v_and_b32 v30, v16, v10
    v_and_b32 v31, v16, v11
    s_nop 1
    v_mfma_f32_16x16x32_bf16 v[24:27], v[28:31], v[64:67], 0
    s_waitcnt vmcnt(26)
    v_perm_b32 v16, v32, v32, s83
    v_and_b32 v28, v16, v8
    v_and_b32 v29, v16, v9
    v_and_b32 v30, v16, v10
    v_and_b32 v31, v16, v11
    s_nop 1
    v_mfma_f32_16x16x32_bf16 v[24:27], v[28:31], v[68:71], v[24:27]
    s_waitcnt vmcnt(25)
    v_perm_b32 v16, v33, v33, s82
    v_and_b32 v28, v16, v8
    v_and_b32 v29, v16, v9
    v_and_b32 v30, v16, v10
    v_and_b32 v31, v16, v11
    s_nop 1
    v_mfma_f32_16x16x32_bf16 v[24:27], v[28:31], v[72:75], v[24:27]
    s_waitcnt vmcnt(24)
    v_perm_b32 v16, v33, v33, s83
    v_and_b32 v28, v16, v8
    v_and_b32 v29, v16, v9
    v_and_b32 v30, v16, v10
    v_and_b32 v31, v16, v11
    s_nop 1
    v_mfma_f32_16x16x32_bf16 v[24:27], v[28:31], v[76:79], v[24:27]
    s_waitcnt vmcnt(23)
    v_perm_b32 v16, v34, v34, s82
    v_and_b32 v28, v16, v8
    v_and_b32 v29, v16, v9
    v_and_b32 v30, v16, v10
    v_and_b32 v31, v16, v11
    s_nop 1
    v_mfma_f32_16x16x32_bf16 v[24:27], v[28:31], v[80:83], v[24:27]
    s_waitcnt vmcnt(22)
    v_perm_b32 v16, v34, v34, s83
    v_and_b32 v28, v16, v8
    v_and_b32 v29, v16, v9
    v_and_b32 v30, v16, v10
    v_and_b32 v31, v16, v11
    s_nop 1
    v_mfma_f32_16x16x32_bf16 v[24:27], v[28:31], v[84:87], v[24:27]
    s_waitcnt vmcnt(21)
    v_perm_b32 v16, v35, v35, s82
    v_and_b32 v28, v16, v8
    v_and_b32 v29, v16, v9
    v_and_b32 v30, v16, v10
    v_and_b32 v31, v16, v11
    s_nop 1
    v_mfma_f32_16x16x32_bf16 v[24:27], v[28:31], v[88:91], v[24:27]
    s_waitcnt vmcnt(20)
    v_perm_b32 v16, v35, v35, s83
    v_and_b32 v28, v16, v8
    v_and_b32 v29, v16, v9
    v_and_b32 v30, v16, v10
    v_and_b32 v31, v16, v11
    s_nop 1
    v_mfma_f32_16x16x32_bf16 v[24:27], v[28:31], v[92:95], v[24:27]
    s_waitcnt vmcnt(19)
    v_perm_b32 v16, v36, v36, s82
    v_and_b32 v28, v16, v8
    v_and_b32 v29, v16, v9
    v_and_b32 v30, v16, v10
    v_and_b32 v31, v16, v11
    s_nop 1
    v_mfma_f32_16x16x32_bf16 v[24:27], v[28:31], v[96:99], v[24:27]
    s_waitcnt vmcnt(18)
    v_perm_b32 v16, v36, v36, s83
    v_and_b32 v28, v16, v8
    v_and_b32 v29, v16, v9
    v_and_b32 v30, v16, v10
    v_and_b32 v31, v16, v11
    s_nop 1
    v_mfma_f32_16x16x32_bf16 v[24:27], v[28:31], v[100:103], v[24:27]
    s_waitcnt vmcnt(17)
    v_perm_b32 v16, v37, v37, s82
    v_and_b32 v28, v16, v8
    v_and_b32 v29, v16, v9
    v_and_b32 v30, v16, v10
    v_and_b32 v31, v16, v11
    s_nop 1
    v_mfma_f32_16x16x32_bf16 v[24:27], v[28:31], v[104:107], v[24:27]
    s_waitcnt vmcnt(16)
    v_perm_b32 v16, v37, v37, s83
    v_and_b32 v28, v16, v8
    v_and_b32 v29, v16, v9
    v_and_b32 v30, v16, v10
    v_and_b32 v31, v16, v11
    s_nop 1
    v_mfma_f32_16x16x32_bf16 v[24:27], v[28:31], v[108:111], v[24:27]
    s_waitcnt vmcnt(15)
    v_perm_b32 v16, v38, v38, s82
    v_and_b32 v28, v16, v8
    v_and_b32 v29, v16, v9
    v_and_b32 v30, v16, v10
    v_and_b32 v31, v16, v11
    s_nop 1
    v_mfma_f32_16x16x32_bf16 v[24:27], v[28:31], v[112:115], v[24:27]
    s_waitcnt vmcnt(14)
    v_perm_b32 v16, v38, v38, s83
    v_and_b32 v28, v16, v8
    v_and_b32 v29, v16, v9
    v_and_b32 v30, v16, v10
    v_and_b32 v31, v16, v11
    s_nop 1
    v_mfma_f32_16x16x32_bf16 v[24:27], v[28:31], v[116:119], v[24:27]
    s_waitcnt vmcnt(13)
    v_perm_b32 v16, v39, v39, s82
    v_and_b32 v28, v16, v8
    v_and_b32 v29, v16, v9
    v_and_b32 v30, v16, v10
    v_and_b32 v31, v16, v11
    s_nop 1
    v_mfma_f32_16x16x32_bf16 v[24:27], v[28:31], v[120:123], v[24:27]
    s_waitcnt vmcnt(12)
    v_perm_b32 v16, v39, v39, s83
    v_and_b32 v28, v16, v8
    v_and_b32 v29, v16, v9
    v_and_b32 v30, v16, v10
    v_and_b32 v31, v16, v11
    s_nop 1
    v_mfma_f32_16x16x32_bf16 v[24:27], v[28:31], v[124:127], v[24:27]
    s_waitcnt vmcnt(11)
    v_perm_b32 v16, v40, v40, s82
    v_and_b32 v28, v16, v8
    v_and_b32 v29, v16, v9
    v_and_b32 v30, v16, v10
    v_and_b32 v31, v16, v11
    s_nop 1
    v_mfma_f32_16x16x32_bf16 v[24:27], v[28:31], v[128:131], v[24:27]
    s_waitcnt vmcnt(10)
    v_perm_b32 v16, v40, v40, s83
    v_and_b32 v28, v16, v8
    v_and_b32 v29, v16, v9
    v_and_b32 v30, v16, v10
    v_and_b32 v31, v16, v11
    s_nop 1
    v_mfma_f32_16x16x32_bf16 v[24:27], v[28:31], v[132:135], v[24:27]
    s_waitcnt vmcnt(9)
    v_perm_b32 v16, v41, v41, s82
    v_and_b32 v28, v16, v8
    v_and_b32 v29, v16, v9
    v_and_b32 v30, v16, v10
    v_and_b32 v31, v16, v11
    s_nop 1
    v_mfma_f32_16x16x32_bf16 v[24:27], v[28:31], v[136:139], v[24:27]
    s_waitcnt vmcnt(8)
    v_perm_b32 v16, v41, v41, s83
    v_and_b32 v28, v16, v8
    v_and_b32 v29, v16, v9
    v_and_b32 v30, v16, v10
    v_and_b32 v31, v16, v11
    s_nop 1
    v_mfma_f32_16x16x32_bf16 v[24:27], v[28:31], v[140:143], v[24:27]
    s_waitcnt vmcnt(7)
    v_perm_b32 v16, v42, v42, s82
    v_and_b32 v28, v16, v8
    v_and_b32 v29, v16, v9
    v_and_b32 v30, v16, v10
    v_and_b32 v31, v16, v11
    s_nop 1
    v_mfma_f32_16x16x32_bf16 v[24:27], v[28:31], v[144:147], v[24:27]
    s_waitcnt vmcnt(6)
    v_perm_b32 v16, v42, v42, s83
    v_and_b32 v28, v16, v8
    v_and_b32 v29, v16, v9
    v_and_b32 v30, v16, v10
    v_and_b32 v31, v16, v11
    s_nop 1
    v_mfma_f32_16x16x32_bf16 v[24:27], v[28:31], v[148:151], v[24:27]
    s_waitcnt vmcnt(5)
    v_perm_b32 v16, v43, v43, s82
    v_and_b32 v28, v16, v8
    v_and_b32 v29, v16, v9
    v_and_b32 v30, v16, v10
    v_and_b32 v31, v16, v11
    s_nop 1
    v_mfma_f32_16x16x32_bf16 v[24:27], v[28:31], v[152:155], v[24:27]
    s_waitcnt vmcnt(4)
    v_perm_b32 v16, v43, v43, s83
    v_and_b32 v28, v16, v8
    v_and_b32 v29, v16, v9
    v_and_b32 v30, v16, v10
    v_and_b32 v31, v16, v11
    s_nop 1
    v_mfma_f32_16x16x32_bf16 v[24:27], v[28:31], v[156:159], v[24:27]
    s_waitcnt vmcnt(3)
    v_perm_b32 v16, v44, v44, s82
    v_and_b32 v28, v16, v8
    v_and_b32 v29, v16, v9
    v_and_b32 v30, v16, v10
    v_and_b32 v31, v16, v11
    s_nop 1
    v_mfma_f32_16x16x32_bf16 v[24:27], v[28:31], v[160:163], v[24:27]
    s_waitcnt vmcnt(2)
    v_perm_b32 v16, v44, v44, s83
    v_and_b32 v28, v16, v8
    v_and_b32 v29, v16, v9
    v_and_b32 v30, v16, v10
    v_and_b32 v31, v16, v11
    s_nop 1
    v_mfma_f32_16x16x32_bf16 v[24:27], v[28:31], v[164:167], v[24:27]
    s_waitcnt vmcnt(1)
    v_perm_b32 v16, v45, v45, s82
    v_and_b32 v28, v16, v8
    v_and_b32 v29, v16, v9
    v_and_b32 v30, v16, v10
    v_and_b32 v31, v16, v11
    s_nop 1
    v_mfma_f32_16x16x32_bf16 v[24:27], v[28:31], v[168:171], v[24:27]
    s_waitcnt vmcnt(0)
    v_perm_b32 v16, v45, v45, s83
    v_and_b32 v28, v16, v8
    v_and_b32 v29, v16, v9
    v_and_b32 v30, v16, v10
    v_and_b32 v31, v16, v11
    s_nop 1
    v_mfma_f32_16x16x32_bf16 v[24:27], v[28:31], v[172:175], v[24:27]
    s_nop 7
    v_mov_b32 v25, v26
    v_lshlrev_b32 v6, 5, v12
    v_lshl_add_u32 v6, v13, 3, v6
    s_lshl_b32 s68, s61, 11
    s_lshl_b32 s69, s65, 9
    s_add_u32 s68, s68, s69
    s_lshl_b32 s69, s66, 14
    s_add_u32 s68, s68, s69
    buffer_store_dwordx2 v[24:25], v6, s[12:15], s68 offen offset:0 sc1
    s_waitcnt vmcnt(0)
    v_mov_b32 v6, 1
    s_mov_b64 exec, 1
    buffer_atomic_add v6, v3, s[16:19], 0 offen sc0
    s_waitcnt vmcnt(0)
    v_readfirstlane_b32 s65, v6
    s_cmp_lg_u32 s65, 127
    s_cbranch_scc1 L_notlast
    v_mov_b32 v6, 1
    buffer_store_dword v6, v3, s[16:19], 0 offen offset:64 sc1
    buffer_store_dword v6, v3, s[16:19], 0 offen offset:192 sc1
L_notlast:
    s_mov_b64 exec, -1
L_h3_b1:
    s_barrier
    s_barrier
    s_branch L_norel
    s_mov_b32 s24, s40
    s_mov_b32 s25, s41
    s_mov_b32 s26, 3670016
    s_mov_b32 s27, 0x20000
    v_mul_u32_u24 v4, 896, v12
    v_lshl_add_u32 v4, v13, 4, v4
    s_mul_i32 s65, s2, 14336
    buffer_load_dwordx4 v[64:67], v4, s[24:27], s65 offen offset:0 nt
    buffer_load_dwordx4 v[68:71], v4, s[24:27], s65 offen offset:64 nt
    buffer_load_dwordx4 v[72:75], v4, s[24:27], s65 offen offset:128 nt
    buffer_load_dwordx4 v[76:79], v4, s[24:27], s65 offen offset:192 nt
    buffer_load_dwordx4 v[80:83], v4, s[24:27], s65 offen offset:256 nt
    buffer_load_dwordx4 v[84:87], v4, s[24:27], s65 offen offset:320 nt
    buffer_load_dwordx4 v[88:91], v4, s[24:27], s65 offen offset:384 nt
    buffer_load_dwordx4 v[92:95], v4, s[24:27], s65 offen offset:448 nt
    buffer_load_dwordx4 v[96:99], v4, s[24:27], s65 offen offset:512 nt
    buffer_load_dwordx4 v[100:103], v4, s[24:27], s65 offen offset:576 nt
    buffer_load_dwordx4 v[104:107], v4, s[24:27], s65 offen offset:640 nt
    buffer_load_dwordx4 v[108:111], v4, s[24:27], s65 offen offset:704 nt
    buffer_load_dwordx4 v[112:115], v4, s[24:27], s65 offen offset:768 nt
    buffer_load_dwordx4 v[116:119], v4, s[24:27], s65 offen offset:832 nt
    v_lshlrev_b32 v5, 16, v13
    v_lshl_add_u32 v5, v12, 4, v5
    s_lshl_b32 s65, s2, 8
    s_add_u32 s65, s65, 4194304
    s_waitcnt vmcnt(13)
    buffer_store_dwordx4 v[64:67], v5, s[12:15], s65 offen sc1
    s_add_u32 s65, s65, 262144
    s_waitcnt vmcnt(13)
    buffer_store_dwordx4 v[68:71], v5, s[12:15], s65 offen sc1
    s_add_u32 s65, s65, 262144
    s_waitcnt vmcnt(13)
    buffer_store_dwordx4 v[72:75], v5, s[12:15], s65 offen sc1
    s_add_u32 s65, s65, 262144
    s_waitcnt vmcnt(13)
    buffer_store_dwordx4 v[76:79], v5, s[12:15], s65 offen sc1
    s_add_u32 s65, s65, 262144
    s_waitcnt vmcnt(13)
    buffer_store_dwordx4 v[80:83], v5, s[12:15], s65 offen sc1
    s_add_u32 s65, s65, 262144
    s_waitcnt vmcnt(13)
    buffer_store_dwordx4 v[84:87], v5, s[12:15], s65 offen sc1
    s_add_u32 s65, s65, 262144
    s_waitcnt vmcnt(13)
    buffer_store_dwordx4 v[88:91], v5, s[12:15], s65 offen sc1
    s_add_u32 s65, s65, 262144
    s_waitcnt vmcnt(13)
    buffer_store_dwordx4 v[92:95], v5, s[12:15], s65 offen sc1
    s_add_u32 s65, s65, 262144
    s_waitcnt vmcnt(13)
    buffer_store_dwordx4 v[96:99], v5, s[12:15], s65 offen sc1
    s_add_u32 s65, s65, 262144
    s_waitcnt vmcnt(13)
    buffer_store_dwordx4 v[100:103], v5, s[12:15], s65 offen sc1
    s_add_u32 s65, s65, 262144
    s_waitcnt vmcnt(13)
    buffer_store_dwordx4 v[104:107], v5, s[12:15], s65 offen sc1
    s_add_u32 s65, s65, 262144
    s_waitcnt vmcnt(13)
    buffer_store_dwordx4 v[108:111], v5, s[12:15], s65 offen sc1
    s_add_u32 s65, s65, 262144
    s_waitcnt vmcnt(13)
    buffer_store_dwordx4 v[112:115], v5, s[12:15], s65 offen sc1
    s_add_u32 s65, s65, 262144
    s_waitcnt vmcnt(13)
    buffer_store_dwordx4 v[116:119], v5, s[12:15], s65 offen sc1
    s_add_u32 s65, s65, 262144
    s_waitcnt vmcnt(0)
    v_mov_b32 v6, 1
    s_mov_b32 s73, 81920
    s_mov_b64 exec, 1
    buffer_atomic_add v6, v3, s[12:15], s73 offen offset:640 sc0
    s_waitcnt vmcnt(0)
    v_readfirstlane_b32 s72, v6
    s_cmp_lg_u32 s72, 255
    s_cbranch_scc1 L_sigw
    s_mov_b64 exec, 0xff
    v_lshlrev_b32 v7, 10, v1
    v_mov_b32 v6, 1
    buffer_store_dword v6, v7, s[12:15], s73 offen offset:416 sc1
L_sigw:
    s_mov_b64 exec, -1
L_norel:
    s_or_b32 s65, s62, 8
    s_cmp_lg_u32 s65, 31
    s_cbranch_scc1 L_hfinal
    s_cmp_ge_u32 s61, 7
    s_cbranch_scc1 L_hfinal
    s_lshl_b32 s65, s61, 1
    s_lshr_b32 s66, s62, 3
    s_add_u32 s65, s65, s66
    s_sub_u32 s65, s65, 2
    s_mov_b32 s24, s44
    s_mov_b32 s25, s45
    s_mov_b32 s26, 1605632
    s_mov_b32 s27, 0x20000
    s_mov_b32 s28, s46
    s_mov_b32 s29, s47
    s_mov_b32 s30, 3584
    s_mov_b32 s31, 0x20000
    v_mul_u32_u24 v4, 224, v13
    buffer_load_dwordx4 v[192:195], v4, s[20:23], 0 offen offset:0
    buffer_load_dwordx4 v[196:199], v4, s[20:23], 0 offen offset:16
    buffer_load_dwordx4 v[200:203], v4, s[20:23], 0 offen offset:32
    buffer_load_dwordx4 v[204:207], v4, s[20:23], 0 offen offset:48
    buffer_load_dwordx4 v[208:211], v4, s[20:23], 0 offen offset:64
    buffer_load_dwordx4 v[212:215], v4, s[20:23], 0 offen offset:80
    buffer_load_dwordx4 v[216:219], v4, s[20:23], 0 offen offset:96
    buffer_load_dwordx4 v[220:223], v4, s[20:23], 0 offen offset:112
    buffer_load_dwordx4 v[224:227], v4, s[20:23], 0 offen offset:128
    buffer_load_dwordx4 v[228:231], v4, s[20:23], 0 offen offset:144
    buffer_load_dwordx4 v[232:235], v4, s[20:23], 0 offen offset:160
    buffer_load_dwordx4 v[236:239], v4, s[20:23], 0 offen offset:176
    buffer_load_dwordx4 v[240:243], v4, s[20:23], 0 offen offset:192
    buffer_load_dwordx4 v[244:247], v4, s[20:23], 0 offen offset:208
    v_lshlrev_b32 v6, 4, v12
    v_lshl_add_u32 v6, v13, 2, v6
    s_lshl_b32 s66, s65, 8
    buffer_load_dword v248, v6, s[28:31], s66 offen
    s_mov_b32 s68, 401408
    v_mul_lo_u32 v5, v13, s68
    v_lshl_add_u32 v5, v12, 4, v5
    s_mov_b32 s68, s66
    buffer_load_dwordx4 v[64:67], v5, s[24:27], s68 offen nt
    s_add_u32 s68, s68, 3584
    buffer_load_dwordx4 v[68:71], v5, s[24:27], s68 offen nt
    s_add_u32 s68, s68, 3584
    buffer_load_dwordx4 v[72:75], v5, s[24:27], s68 offen nt
    s_add_u32 s68, s68, 3584
    buffer_load_dwordx4 v[76:79], v5, s[24:27], s68 offen nt
    s_add_u32 s68, s68, 3584
    buffer_load_dwordx4 v[80:83], v5, s[24:27], s68 offen nt
    s_add_u32 s68, s68, 3584
    buffer_load_dwordx4 v[84:87], v5, s[24:27], s68 offen nt
    s_add_u32 s68, s68, 3584
    buffer_load_dwordx4 v[88:91], v5, s[24:27], s68 offen nt
    s_add_u32 s68, s68, 3584
    buffer_load_dwordx4 v[92:95], v5, s[24:27], s68 offen nt
    s_add_u32 s68, s68, 3584
    buffer_load_dwordx4 v[96:99], v5, s[24:27], s68 offen nt
    s_add_u32 s68, s68, 3584
    buffer_load_dwordx4 v[100:103], v5, s[24:27], s68 offen nt
    s_add_u32 s68, s68, 3584
    buffer_load_dwordx4 v[104:107], v5, s[24:27], s68 offen nt
    s_add_u32 s68, s68, 3584
    buffer_load_dwordx4 v[108:111], v5, s[24:27], s68 offen nt
    s_add_u32 s68, s68, 3584
    buffer_load_dwordx4 v[112:115], v5, s[24:27], s68 offen nt
    s_add_u32 s68, s68, 3584
    buffer_load_dwordx4 v[116:119], v5, s[24:27], s68 offen nt
    s_add_u32 s68, s68, 3584
    buffer_load_dwordx4 v[120:123], v5, s[24:27], s68 offen nt
    s_add_u32 s68, s68, 3584
    buffer_load_dwordx4 v[124:127], v5, s[24:27], s68 offen nt
    s_add_u32 s68, s68, 3584
    buffer_load_dwordx4 v[128:131], v5, s[24:27], s68 offen nt
    s_add_u32 s68, s68, 3584
    buffer_load_dwordx4 v[132:135], v5, s[24:27], s68 offen nt
    s_add_u32 s68, s68, 3584
    buffer_load_dwordx4 v[136:139], v5, s[24:27], s68 offen nt
    s_add_u32 s68, s68, 3584
    buffer_load_dwordx4 v[140:143], v5, s[24:27], s68 offen nt
    s_add_u32 s68, s68, 3584
    buffer_load_dwordx4 v[144:147], v5, s[24:27], s68 offen nt
    s_add_u32 s68, s68, 3584
    buffer_load_dwordx4 v[148:151], v5, s[24:27], s68 offen nt
    s_add_u32 s68, s68, 3584
    buffer_load_dwordx4 v[152:155], v5, s[24:27], s68 offen nt
    s_add_u32 s68, s68, 3584
    buffer_load_dwordx4 v[156:159], v5, s[24:27], s68 offen nt
    s_add_u32 s68, s68, 3584
    buffer_load_dwordx4 v[160:163], v5, s[24:27], s68 offen nt
    s_add_u32 s68, s68, 3584
    buffer_load_dwordx4 v[164:167], v5, s[24:27], s68 offen nt
    s_add_u32 s68, s68, 3584
    buffer_load_dwordx4 v[168:171], v5, s[24:27], s68 offen nt
    s_add_u32 s68, s68, 3584
    buffer_load_dwordx4 v[172:175], v5, s[24:27], s68 offen nt
    s_add_u32 s68, s68, 3584
    s_waitcnt vmcnt(27)
    v_perm_b32 v16, v192, v192, s82
    v_and_b32 v28, v16, v8
    v_and_b32 v29, v16, v9
    v_and_b32 v30, v16, v10
    v_and_b32 v31, v16, v11
    s_nop 1
    v_mfma_f32_16x16x32_bf16 v[24:27], v[28:31], v[64:67], 0
    s_waitcnt vmcnt(26)
    v_perm_b32 v16, v192, v192, s83
    v_and_b32 v28, v16, v8
    v_and_b32 v29, v16, v9
    v_and_b32 v30, v16, v10
    v_and_b32 v31, v16, v11
    s_nop 1
    v_mfma_f32_16x16x32_bf16 v[24:27], v[28:31], v[68:71], v[24:27]
    s_waitcnt vmcnt(25)
    v_perm_b32 v16, v193, v193, s82
    v_and_b32 v28, v16, v8
    v_and_b32 v29, v16, v9
    v_and_b32 v30, v16, v10
    v_and_b32 v31, v16, v11
    s_nop 1
    v_mfma_f32_16x16x32_bf16 v[24:27], v[28:31], v[72:75], v[24:27]
    s_waitcnt vmcnt(24)
    v_perm_b32 v16, v193, v193, s83
    v_and_b32 v28, v16, v8
    v_and_b32 v29, v16, v9
    v_and_b32 v30, v16, v10
    v_and_b32 v31, v16, v11
    s_nop 1
    v_mfma_f32_16x16x32_bf16 v[24:27], v[28:31], v[76:79], v[24:27]
    s_waitcnt vmcnt(23)
    v_perm_b32 v16, v194, v194, s82
    v_and_b32 v28, v16, v8
    v_and_b32 v29, v16, v9
    v_and_b32 v30, v16, v10
    v_and_b32 v31, v16, v11
    s_nop 1
    v_mfma_f32_16x16x32_bf16 v[24:27], v[28:31], v[80:83], v[24:27]
    s_waitcnt vmcnt(22)
    v_perm_b32 v16, v194, v194, s83
    v_and_b32 v28, v16, v8
    v_and_b32 v29, v16, v9
    v_and_b32 v30, v16, v10
    v_and_b32 v31, v16, v11
    s_nop 1
    v_mfma_f32_16x16x32_bf16 v[24:27], v[28:31], v[84:87], v[24:27]
    s_waitcnt vmcnt(21)
    v_perm_b32 v16, v195, v195, s82
    v_and_b32 v28, v16, v8
    v_and_b32 v29, v16, v9
    v_and_b32 v30, v16, v10
    v_and_b32 v31, v16, v11
    s_nop 1
    v_mfma_f32_16x16x32_bf16 v[24:27], v[28:31], v[88:91], v[24:27]
    s_waitcnt vmcnt(20)
    v_perm_b32 v16, v195, v195, s83
    v_and_b32 v28, v16, v8
    v_and_b32 v29, v16, v9
    v_and_b32 v30, v16, v10
    v_and_b32 v31, v16, v11
    s_nop 1
    v_mfma_f32_16x16x32_bf16 v[24:27], v[28:31], v[92:95], v[24:27]
    s_waitcnt vmcnt(19)
    v_perm_b32 v16, v196, v196, s82
    v_and_b32 v28, v16, v8
    v_and_b32 v29, v16, v9
    v_and_b32 v30, v16, v10
    v_and_b32 v31, v16, v11
    s_nop 1
    v_mfma_f32_16x16x32_bf16 v[24:27], v[28:31], v[96:99], v[24:27]
    s_waitcnt vmcnt(18)
    v_perm_b32 v16, v196, v196, s83
    v_and_b32 v28, v16, v8
    v_and_b32 v29, v16, v9
    v_and_b32 v30, v16, v10
    v_and_b32 v31, v16, v11
    s_nop 1
    v_mfma_f32_16x16x32_bf16 v[24:27], v[28:31], v[100:103], v[24:27]
    s_waitcnt vmcnt(17)
    v_perm_b32 v16, v197, v197, s82
    v_and_b32 v28, v16, v8
    v_and_b32 v29, v16, v9
    v_and_b32 v30, v16, v10
    v_and_b32 v31, v16, v11
    s_nop 1
    v_mfma_f32_16x16x32_bf16 v[24:27], v[28:31], v[104:107], v[24:27]
    s_waitcnt vmcnt(16)
    v_perm_b32 v16, v197, v197, s83
    v_and_b32 v28, v16, v8
    v_and_b32 v29, v16, v9
    v_and_b32 v30, v16, v10
    v_and_b32 v31, v16, v11
    s_nop 1
    v_mfma_f32_16x16x32_bf16 v[24:27], v[28:31], v[108:111], v[24:27]
    s_waitcnt vmcnt(15)
    v_perm_b32 v16, v198, v198, s82
    v_and_b32 v28, v16, v8
    v_and_b32 v29, v16, v9
    v_and_b32 v30, v16, v10
    v_and_b32 v31, v16, v11
    s_nop 1
    v_mfma_f32_16x16x32_bf16 v[24:27], v[28:31], v[112:115], v[24:27]
    s_waitcnt vmcnt(14)
    v_perm_b32 v16, v198, v198, s83
    v_and_b32 v28, v16, v8
    v_and_b32 v29, v16, v9
    v_and_b32 v30, v16, v10
    v_and_b32 v31, v16, v11
    s_nop 1
    v_mfma_f32_16x16x32_bf16 v[24:27], v[28:31], v[116:119], v[24:27]
    s_waitcnt vmcnt(13)
    v_perm_b32 v16, v199, v199, s82
    v_and_b32 v28, v16, v8
    v_and_b32 v29, v16, v9
    v_and_b32 v30, v16, v10
    v_and_b32 v31, v16, v11
    s_nop 1
    v_mfma_f32_16x16x32_bf16 v[24:27], v[28:31], v[120:123], v[24:27]
    s_waitcnt vmcnt(12)
    v_perm_b32 v16, v199, v199, s83
    v_and_b32 v28, v16, v8
    v_and_b32 v29, v16, v9
    v_and_b32 v30, v16, v10
    v_and_b32 v31, v16, v11
    s_nop 1
    v_mfma_f32_16x16x32_bf16 v[24:27], v[28:31], v[124:127], v[24:27]
    s_waitcnt vmcnt(11)
    v_perm_b32 v16, v200, v200, s82
    v_and_b32 v28, v16, v8
    v_and_b32 v29, v16, v9
    v_and_b32 v30, v16, v10
    v_and_b32 v31, v16, v11
    s_nop 1
    v_mfma_f32_16x16x32_bf16 v[24:27], v[28:31], v[128:131], v[24:27]
    s_waitcnt vmcnt(10)
    v_perm_b32 v16, v200, v200, s83
    v_and_b32 v28, v16, v8
    v_and_b32 v29, v16, v9
    v_and_b32 v30, v16, v10
    v_and_b32 v31, v16, v11
    s_nop 1
    v_mfma_f32_16x16x32_bf16 v[24:27], v[28:31], v[132:135], v[24:27]
    s_waitcnt vmcnt(9)
    v_perm_b32 v16, v201, v201, s82
    v_and_b32 v28, v16, v8
    v_and_b32 v29, v16, v9
    v_and_b32 v30, v16, v10
    v_and_b32 v31, v16, v11
    s_nop 1
    v_mfma_f32_16x16x32_bf16 v[24:27], v[28:31], v[136:139], v[24:27]
    s_waitcnt vmcnt(8)
    v_perm_b32 v16, v201, v201, s83
    v_and_b32 v28, v16, v8
    v_and_b32 v29, v16, v9
    v_and_b32 v30, v16, v10
    v_and_b32 v31, v16, v11
    s_nop 1
    v_mfma_f32_16x16x32_bf16 v[24:27], v[28:31], v[140:143], v[24:27]
    s_waitcnt vmcnt(7)
    v_perm_b32 v16, v202, v202, s82
    v_and_b32 v28, v16, v8
    v_and_b32 v29, v16, v9
    v_and_b32 v30, v16, v10
    v_and_b32 v31, v16, v11
    s_nop 1
    v_mfma_f32_16x16x32_bf16 v[24:27], v[28:31], v[144:147], v[24:27]
    s_waitcnt vmcnt(6)
    v_perm_b32 v16, v202, v202, s83
    v_and_b32 v28, v16, v8
    v_and_b32 v29, v16, v9
    v_and_b32 v30, v16, v10
    v_and_b32 v31, v16, v11
    s_nop 1
    v_mfma_f32_16x16x32_bf16 v[24:27], v[28:31], v[148:151], v[24:27]
    s_waitcnt vmcnt(5)
    v_perm_b32 v16, v203, v203, s82
    v_and_b32 v28, v16, v8
    v_and_b32 v29, v16, v9
    v_and_b32 v30, v16, v10
    v_and_b32 v31, v16, v11
    s_nop 1
    v_mfma_f32_16x16x32_bf16 v[24:27], v[28:31], v[152:155], v[24:27]
    s_waitcnt vmcnt(4)
    v_perm_b32 v16, v203, v203, s83
    v_and_b32 v28, v16, v8
    v_and_b32 v29, v16, v9
    v_and_b32 v30, v16, v10
    v_and_b32 v31, v16, v11
    s_nop 1
    v_mfma_f32_16x16x32_bf16 v[24:27], v[28:31], v[156:159], v[24:27]
    s_waitcnt vmcnt(3)
    v_perm_b32 v16, v204, v204, s82
    v_and_b32 v28, v16, v8
    v_and_b32 v29, v16, v9
    v_and_b32 v30, v16, v10
    v_and_b32 v31, v16, v11
    s_nop 1
    v_mfma_f32_16x16x32_bf16 v[24:27], v[28:31], v[160:163], v[24:27]
    s_waitcnt vmcnt(2)
    v_perm_b32 v16, v204, v204, s83
    v_and_b32 v28, v16, v8
    v_and_b32 v29, v16, v9
    v_and_b32 v30, v16, v10
    v_and_b32 v31, v16, v11
    s_nop 1
    v_mfma_f32_16x16x32_bf16 v[24:27], v[28:31], v[164:167], v[24:27]
    s_waitcnt vmcnt(1)
    v_perm_b32 v16, v205, v205, s82
    v_and_b32 v28, v16, v8
    v_and_b32 v29, v16, v9
    v_and_b32 v30, v16, v10
    v_and_b32 v31, v16, v11
    s_nop 1
    v_mfma_f32_16x16x32_bf16 v[24:27], v[28:31], v[168:171], v[24:27]
    s_waitcnt vmcnt(0)
    v_perm_b32 v16, v205, v205, s83
    v_and_b32 v28, v16, v8
    v_and_b32 v29, v16, v9
    v_and_b32 v30, v16, v10
    v_and_b32 v31, v16, v11
    s_nop 1
    v_mfma_f32_16x16x32_bf16 v[24:27], v[28:31], v[172:175], v[24:27]
    buffer_load_dwordx4 v[64:67], v5, s[24:27], s68 offen nt
    s_add_u32 s68, s68, 3584
    buffer_load_dwordx4 v[68:71], v5, s[24:27], s68 offen nt
    s_add_u32 s68, s68, 3584
    buffer_load_dwordx4 v[72:75], v5, s[24:27], s68 offen nt
    s_add_u32 s68, s68, 3584
    buffer_load_dwordx4 v[76:79], v5, s[24:27], s68 offen nt
    s_add_u32 s68, s68, 3584
    buffer_load_dwordx4 v[80:83], v5, s[24:27], s68 offen nt
    s_add_u32 s68, s68, 3584
    buffer_load_dwordx4 v[84:87], v5, s[24:27], s68 offen nt
    s_add_u32 s68, s68, 3584
    buffer_load_dwordx4 v[88:91], v5, s[24:27], s68 offen nt
    s_add_u32 s68, s68, 3584
    buffer_load_dwordx4 v[92:95], v5, s[24:27], s68 offen nt
    s_add_u32 s68, s68, 3584
    buffer_load_dwordx4 v[96:99], v5, s[24:27], s68 offen nt
    s_add_u32 s68, s68, 3584
    buffer_load_dwordx4 v[100:103], v5, s[24:27], s68 offen nt
    s_add_u32 s68, s68, 3584
    buffer_load_dwordx4 v[104:107], v5, s[24:27], s68 offen nt
    s_add_u32 s68, s68, 3584
    buffer_load_dwordx4 v[108:111], v5, s[24:27], s68 offen nt
    s_add_u32 s68, s68, 3584
    buffer_load_dwordx4 v[112:115], v5, s[24:27], s68 offen nt
    s_add_u32 s68, s68, 3584
    buffer_load_dwordx4 v[116:119], v5, s[24:27], s68 offen nt
    s_add_u32 s68, s68, 3584
    buffer_load_dwordx4 v[120:123], v5, s[24:27], s68 offen nt
    s_add_u32 s68, s68, 3584
    buffer_load_dwordx4 v[124:127], v5, s[24:27], s68 offen nt
    s_add_u32 s68, s68, 3584
    buffer_load_dwordx4 v[128:131], v5, s[24:27], s68 offen nt
    s_add_u32 s68, s68, 3584
    buffer_load_dwordx4 v[132:135], v5, s[24:27], s68 offen nt
    s_add_u32 s68, s68, 3584
    buffer_load_dwordx4 v[136:139], v5, s[24:27], s68 offen nt
    s_add_u32 s68, s68, 3584
    buffer_load_dwordx4 v[140:143], v5, s[24:27], s68 offen nt
    s_add_u32 s68, s68, 3584
    buffer_load_dwordx4 v[144:147], v5, s[24:27], s68 offen nt
    s_add_u32 s68, s68, 3584
    buffer_load_dwordx4 v[148:151], v5, s[24:27], s68 offen nt
    s_add_u32 s68, s68, 3584
    buffer_load_dwordx4 v[152:155], v5, s[24:27], s68 offen nt
    s_add_u32 s68, s68, 3584
    buffer_load_dwordx4 v[156:159], v5, s[24:27], s68 offen nt
    s_add_u32 s68, s68, 3584
    buffer_load_dwordx4 v[160:163], v5, s[24:27], s68 offen nt
    s_add_u32 s68, s68, 3584
    buffer_load_dwordx4 v[164:167], v5, s[24:27], s68 offen nt
    s_add_u32 s68, s68, 3584
    buffer_load_dwordx4 v[168:171], v5, s[24:27], s68 offen nt
    s_add_u32 s68, s68, 3584
    buffer_load_dwordx4 v[172:175], v5, s[24:27], s68 offen nt
    s_add_u32 s68, s68, 3584
    s_waitcnt vmcnt(27)
    v_perm_b32 v16, v206, v206, s82
    v_and_b32 v28, v16, v8
    v_and_b32 v29, v16, v9
    v_and_b32 v30, v16, v10
    v_and_b32 v31, v16, v11
    s_nop 1
    v_mfma_f32_16x16x32_bf16 v[24:27], v[28:31], v[64:67], v[24:27]
    s_waitcnt vmcnt(26)
    v_perm_b32 v16, v206, v206, s83
    v_and_b32 v28, v16, v8
    v_and_b32 v29, v16, v9
    v_and_b32 v30, v16, v10
    v_and_b32 v31, v16, v11
    s_nop 1
    v_mfma_f32_16x16x32_bf16 v[24:27], v[28:31], v[68:71], v[24:27]
    s_waitcnt vmcnt(25)
    v_perm_b32 v16, v207, v207, s82
    v_and_b32 v28, v16, v8
    v_and_b32 v29, v16, v9
    v_and_b32 v30, v16, v10
    v_and_b32 v31, v16, v11
    s_nop 1
    v_mfma_f32_16x16x32_bf16 v[24:27], v[28:31], v[72:75], v[24:27]
    s_waitcnt vmcnt(24)
    v_perm_b32 v16, v207, v207, s83
    v_and_b32 v28, v16, v8
    v_and_b32 v29, v16, v9
    v_and_b32 v30, v16, v10
    v_and_b32 v31, v16, v11
    s_nop 1
    v_mfma_f32_16x16x32_bf16 v[24:27], v[28:31], v[76:79], v[24:27]
    s_waitcnt vmcnt(23)
    v_perm_b32 v16, v208, v208, s82
    v_and_b32 v28, v16, v8
    v_and_b32 v29, v16, v9
    v_and_b32 v30, v16, v10
    v_and_b32 v31, v16, v11
    s_nop 1
    v_mfma_f32_16x16x32_bf16 v[24:27], v[28:31], v[80:83], v[24:27]
    s_waitcnt vmcnt(22)
    v_perm_b32 v16, v208, v208, s83
    v_and_b32 v28, v16, v8
    v_and_b32 v29, v16, v9
    v_and_b32 v30, v16, v10
    v_and_b32 v31, v16, v11
    s_nop 1
    v_mfma_f32_16x16x32_bf16 v[24:27], v[28:31], v[84:87], v[24:27]
    s_waitcnt vmcnt(21)
    v_perm_b32 v16, v209, v209, s82
    v_and_b32 v28, v16, v8
    v_and_b32 v29, v16, v9
    v_and_b32 v30, v16, v10
    v_and_b32 v31, v16, v11
    s_nop 1
    v_mfma_f32_16x16x32_bf16 v[24:27], v[28:31], v[88:91], v[24:27]
    s_waitcnt vmcnt(20)
    v_perm_b32 v16, v209, v209, s83
    v_and_b32 v28, v16, v8
    v_and_b32 v29, v16, v9
    v_and_b32 v30, v16, v10
    v_and_b32 v31, v16, v11
    s_nop 1
    v_mfma_f32_16x16x32_bf16 v[24:27], v[28:31], v[92:95], v[24:27]
    s_waitcnt vmcnt(19)
    v_perm_b32 v16, v210, v210, s82
    v_and_b32 v28, v16, v8
    v_and_b32 v29, v16, v9
    v_and_b32 v30, v16, v10
    v_and_b32 v31, v16, v11
    s_nop 1
    v_mfma_f32_16x16x32_bf16 v[24:27], v[28:31], v[96:99], v[24:27]
    s_waitcnt vmcnt(18)
    v_perm_b32 v16, v210, v210, s83
    v_and_b32 v28, v16, v8
    v_and_b32 v29, v16, v9
    v_and_b32 v30, v16, v10
    v_and_b32 v31, v16, v11
    s_nop 1
    v_mfma_f32_16x16x32_bf16 v[24:27], v[28:31], v[100:103], v[24:27]
    s_waitcnt vmcnt(17)
    v_perm_b32 v16, v211, v211, s82
    v_and_b32 v28, v16, v8
    v_and_b32 v29, v16, v9
    v_and_b32 v30, v16, v10
    v_and_b32 v31, v16, v11
    s_nop 1
    v_mfma_f32_16x16x32_bf16 v[24:27], v[28:31], v[104:107], v[24:27]
    s_waitcnt vmcnt(16)
    v_perm_b32 v16, v211, v211, s83
    v_and_b32 v28, v16, v8
    v_and_b32 v29, v16, v9
    v_and_b32 v30, v16, v10
    v_and_b32 v31, v16, v11
    s_nop 1
    v_mfma_f32_16x16x32_bf16 v[24:27], v[28:31], v[108:111], v[24:27]
    s_waitcnt vmcnt(15)
    v_perm_b32 v16, v212, v212, s82
    v_and_b32 v28, v16, v8
    v_and_b32 v29, v16, v9
    v_and_b32 v30, v16, v10
    v_and_b32 v31, v16, v11
    s_nop 1
    v_mfma_f32_16x16x32_bf16 v[24:27], v[28:31], v[112:115], v[24:27]
    s_waitcnt vmcnt(14)
    v_perm_b32 v16, v212, v212, s83
    v_and_b32 v28, v16, v8
    v_and_b32 v29, v16, v9
    v_and_b32 v30, v16, v10
    v_and_b32 v31, v16, v11
    s_nop 1
    v_mfma_f32_16x16x32_bf16 v[24:27], v[28:31], v[116:119], v[24:27]
    s_waitcnt vmcnt(13)
    v_perm_b32 v16, v213, v213, s82
    v_and_b32 v28, v16, v8
    v_and_b32 v29, v16, v9
    v_and_b32 v30, v16, v10
    v_and_b32 v31, v16, v11
    s_nop 1
    v_mfma_f32_16x16x32_bf16 v[24:27], v[28:31], v[120:123], v[24:27]
    s_waitcnt vmcnt(12)
    v_perm_b32 v16, v213, v213, s83
    v_and_b32 v28, v16, v8
    v_and_b32 v29, v16, v9
    v_and_b32 v30, v16, v10
    v_and_b32 v31, v16, v11
    s_nop 1
    v_mfma_f32_16x16x32_bf16 v[24:27], v[28:31], v[124:127], v[24:27]
    s_waitcnt vmcnt(11)
    v_perm_b32 v16, v214, v214, s82
    v_and_b32 v28, v16, v8
    v_and_b32 v29, v16, v9
    v_and_b32 v30, v16, v10
    v_and_b32 v31, v16, v11
    s_nop 1
    v_mfma_f32_16x16x32_bf16 v[24:27], v[28:31], v[128:131], v[24:27]
    s_waitcnt vmcnt(10)
    v_perm_b32 v16, v214, v214, s83
    v_and_b32 v28, v16, v8
    v_and_b32 v29, v16, v9
    v_and_b32 v30, v16, v10
    v_and_b32 v31, v16, v11
    s_nop 1
    v_mfma_f32_16x16x32_bf16 v[24:27], v[28:31], v[132:135], v[24:27]
    s_waitcnt vmcnt(9)
    v_perm_b32 v16, v215, v215, s82
    v_and_b32 v28, v16, v8
    v_and_b32 v29, v16, v9
    v_and_b32 v30, v16, v10
    v_and_b32 v31, v16, v11
    s_nop 1
    v_mfma_f32_16x16x32_bf16 v[24:27], v[28:31], v[136:139], v[24:27]
    s_waitcnt vmcnt(8)
    v_perm_b32 v16, v215, v215, s83
    v_and_b32 v28, v16, v8
    v_and_b32 v29, v16, v9
    v_and_b32 v30, v16, v10
    v_and_b32 v31, v16, v11
    s_nop 1
    v_mfma_f32_16x16x32_bf16 v[24:27], v[28:31], v[140:143], v[24:27]
    s_waitcnt vmcnt(7)
    v_perm_b32 v16, v216, v216, s82
    v_and_b32 v28, v16, v8
    v_and_b32 v29, v16, v9
    v_and_b32 v30, v16, v10
    v_and_b32 v31, v16, v11
    s_nop 1
    v_mfma_f32_16x16x32_bf16 v[24:27], v[28:31], v[144:147], v[24:27]
    s_waitcnt vmcnt(6)
    v_perm_b32 v16, v216, v216, s83
    v_and_b32 v28, v16, v8
    v_and_b32 v29, v16, v9
    v_and_b32 v30, v16, v10
    v_and_b32 v31, v16, v11
    s_nop 1
    v_mfma_f32_16x16x32_bf16 v[24:27], v[28:31], v[148:151], v[24:27]
    s_waitcnt vmcnt(5)
    v_perm_b32 v16, v217, v217, s82
    v_and_b32 v28, v16, v8
    v_and_b32 v29, v16, v9
    v_and_b32 v30, v16, v10
    v_and_b32 v31, v16, v11
    s_nop 1
    v_mfma_f32_16x16x32_bf16 v[24:27], v[28:31], v[152:155], v[24:27]
    s_waitcnt vmcnt(4)
    v_perm_b32 v16, v217, v217, s83
    v_and_b32 v28, v16, v8
    v_and_b32 v29, v16, v9
    v_and_b32 v30, v16, v10
    v_and_b32 v31, v16, v11
    s_nop 1
    v_mfma_f32_16x16x32_bf16 v[24:27], v[28:31], v[156:159], v[24:27]
    s_waitcnt vmcnt(3)
    v_perm_b32 v16, v218, v218, s82
    v_and_b32 v28, v16, v8
    v_and_b32 v29, v16, v9
    v_and_b32 v30, v16, v10
    v_and_b32 v31, v16, v11
    s_nop 1
    v_mfma_f32_16x16x32_bf16 v[24:27], v[28:31], v[160:163], v[24:27]
    s_waitcnt vmcnt(2)
    v_perm_b32 v16, v218, v218, s83
    v_and_b32 v28, v16, v8
    v_and_b32 v29, v16, v9
    v_and_b32 v30, v16, v10
    v_and_b32 v31, v16, v11
    s_nop 1
    v_mfma_f32_16x16x32_bf16 v[24:27], v[28:31], v[164:167], v[24:27]
    s_waitcnt vmcnt(1)
    v_perm_b32 v16, v219, v219, s82
    v_and_b32 v28, v16, v8
    v_and_b32 v29, v16, v9
    v_and_b32 v30, v16, v10
    v_and_b32 v31, v16, v11
    s_nop 1
    v_mfma_f32_16x16x32_bf16 v[24:27], v[28:31], v[168:171], v[24:27]
    s_waitcnt vmcnt(0)
    v_perm_b32 v16, v219, v219, s83
    v_and_b32 v28, v16, v8
    v_and_b32 v29, v16, v9
    v_and_b32 v30, v16, v10
    v_and_b32 v31, v16, v11
    s_nop 1
    v_mfma_f32_16x16x32_bf16 v[24:27], v[28:31], v[172:175], v[24:27]
    buffer_load_dwordx4 v[64:67], v5, s[24:27], s68 offen nt
    s_add_u32 s68, s68, 3584
    buffer_load_dwordx4 v[68:71], v5, s[24:27], s68 offen nt
    s_add_u32 s68, s68, 3584
    buffer_load_dwordx4 v[72:75], v5, s[24:27], s68 offen nt
    s_add_u32 s68, s68, 3584
    buffer_load_dwordx4 v[76:79], v5, s[24:27], s68 offen nt
    s_add_u32 s68, s68, 3584
    buffer_load_dwordx4 v[80:83], v5, s[24:27], s68 offen nt
    s_add_u32 s68, s68, 3584
    buffer_load_dwordx4 v[84:87], v5, s[24:27], s68 offen nt
    s_add_u32 s68, s68, 3584
    buffer_load_dwordx4 v[88:91], v5, s[24:27], s68 offen nt
    s_add_u32 s68, s68, 3584
    buffer_load_dwordx4 v[92:95], v5, s[24:27], s68 offen nt
    s_add_u32 s68, s68, 3584
    buffer_load_dwordx4 v[96:99], v5, s[24:27], s68 offen nt
    s_add_u32 s68, s68, 3584
    buffer_load_dwordx4 v[100:103], v5, s[24:27], s68 offen nt
    s_add_u32 s68, s68, 3584
    buffer_load_dwordx4 v[104:107], v5, s[24:27], s68 offen nt
    s_add_u32 s68, s68, 3584
    buffer_load_dwordx4 v[108:111], v5, s[24:27], s68 offen nt
    s_add_u32 s68, s68, 3584
    buffer_load_dwordx4 v[112:115], v5, s[24:27], s68 offen nt
    s_add_u32 s68, s68, 3584
    buffer_load_dwordx4 v[116:119], v5, s[24:27], s68 offen nt
    s_add_u32 s68, s68, 3584
    buffer_load_dwordx4 v[120:123], v5, s[24:27], s68 offen nt
    s_add_u32 s68, s68, 3584
    buffer_load_dwordx4 v[124:127], v5, s[24:27], s68 offen nt
    s_add_u32 s68, s68, 3584
    buffer_load_dwordx4 v[128:131], v5, s[24:27], s68 offen nt
    s_add_u32 s68, s68, 3584
    buffer_load_dwordx4 v[132:135], v5, s[24:27], s68 offen nt
    s_add_u32 s68, s68, 3584
    buffer_load_dwordx4 v[136:139], v5, s[24:27], s68 offen nt
    s_add_u32 s68, s68, 3584
    buffer_load_dwordx4 v[140:143], v5, s[24:27], s68 offen nt
    s_add_u32 s68, s68, 3584
    buffer_load_dwordx4 v[144:147], v5, s[24:27], s68 offen nt
    s_add_u32 s68, s68, 3584
    buffer_load_dwordx4 v[148:151], v5, s[24:27], s68 offen nt
    s_add_u32 s68, s68, 3584
    buffer_load_dwordx4 v[152:155], v5, s[24:27], s68 offen nt
    s_add_u32 s68, s68, 3584
    buffer_load_dwordx4 v[156:159], v5, s[24:27], s68 offen nt
    s_add_u32 s68, s68, 3584
    buffer_load_dwordx4 v[160:163], v5, s[24:27], s68 offen nt
    s_add_u32 s68, s68, 3584
    buffer_load_dwordx4 v[164:167], v5, s[24:27], s68 offen nt
    s_add_u32 s68, s68, 3584
    buffer_load_dwordx4 v[168:171], v5, s[24:27], s68 offen nt
    s_add_u32 s68, s68, 3584
    buffer_load_dwordx4 v[172:175], v5, s[24:27], s68 offen nt
    s_add_u32 s68, s68, 3584
    s_waitcnt vmcnt(27)
    v_perm_b32 v16, v220, v220, s82
    v_and_b32 v28, v16, v8
    v_and_b32 v29, v16, v9
    v_and_b32 v30, v16, v10
    v_and_b32 v31, v16, v11
    s_nop 1
    v_mfma_f32_16x16x32_bf16 v[24:27], v[28:31], v[64:67], v[24:27]
    s_waitcnt vmcnt(26)
    v_perm_b32 v16, v220, v220, s83
    v_and_b32 v28, v16, v8
    v_and_b32 v29, v16, v9
    v_and_b32 v30, v16, v10
    v_and_b32 v31, v16, v11
    s_nop 1
    v_mfma_f32_16x16x32_bf16 v[24:27], v[28:31], v[68:71], v[24:27]
    s_waitcnt vmcnt(25)
    v_perm_b32 v16, v221, v221, s82
    v_and_b32 v28, v16, v8
    v_and_b32 v29, v16, v9
    v_and_b32 v30, v16, v10
    v_and_b32 v31, v16, v11
    s_nop 1
    v_mfma_f32_16x16x32_bf16 v[24:27], v[28:31], v[72:75], v[24:27]
    s_waitcnt vmcnt(24)
    v_perm_b32 v16, v221, v221, s83
    v_and_b32 v28, v16, v8
    v_and_b32 v29, v16, v9
    v_and_b32 v30, v16, v10
    v_and_b32 v31, v16, v11
    s_nop 1
    v_mfma_f32_16x16x32_bf16 v[24:27], v[28:31], v[76:79], v[24:27]
    s_waitcnt vmcnt(23)
    v_perm_b32 v16, v222, v222, s82
    v_and_b32 v28, v16, v8
    v_and_b32 v29, v16, v9
    v_and_b32 v30, v16, v10
    v_and_b32 v31, v16, v11
    s_nop 1
    v_mfma_f32_16x16x32_bf16 v[24:27], v[28:31], v[80:83], v[24:27]
    s_waitcnt vmcnt(22)
    v_perm_b32 v16, v222, v222, s83
    v_and_b32 v28, v16, v8
    v_and_b32 v29, v16, v9
    v_and_b32 v30, v16, v10
    v_and_b32 v31, v16, v11
    s_nop 1
    v_mfma_f32_16x16x32_bf16 v[24:27], v[28:31], v[84:87], v[24:27]
    s_waitcnt vmcnt(21)
    v_perm_b32 v16, v223, v223, s82
    v_and_b32 v28, v16, v8
    v_and_b32 v29, v16, v9
    v_and_b32 v30, v16, v10
    v_and_b32 v31, v16, v11
    s_nop 1
    v_mfma_f32_16x16x32_bf16 v[24:27], v[28:31], v[88:91], v[24:27]
    s_waitcnt vmcnt(20)
    v_perm_b32 v16, v223, v223, s83
    v_and_b32 v28, v16, v8
    v_and_b32 v29, v16, v9
    v_and_b32 v30, v16, v10
    v_and_b32 v31, v16, v11
    s_nop 1
    v_mfma_f32_16x16x32_bf16 v[24:27], v[28:31], v[92:95], v[24:27]
    s_waitcnt vmcnt(19)
    v_perm_b32 v16, v224, v224, s82
    v_and_b32 v28, v16, v8
    v_and_b32 v29, v16, v9
    v_and_b32 v30, v16, v10
    v_and_b32 v31, v16, v11
    s_nop 1
    v_mfma_f32_16x16x32_bf16 v[24:27], v[28:31], v[96:99], v[24:27]
    s_waitcnt vmcnt(18)
    v_perm_b32 v16, v224, v224, s83
    v_and_b32 v28, v16, v8
    v_and_b32 v29, v16, v9
    v_and_b32 v30, v16, v10
    v_and_b32 v31, v16, v11
    s_nop 1
    v_mfma_f32_16x16x32_bf16 v[24:27], v[28:31], v[100:103], v[24:27]
    s_waitcnt vmcnt(17)
    v_perm_b32 v16, v225, v225, s82
    v_and_b32 v28, v16, v8
    v_and_b32 v29, v16, v9
    v_and_b32 v30, v16, v10
    v_and_b32 v31, v16, v11
    s_nop 1
    v_mfma_f32_16x16x32_bf16 v[24:27], v[28:31], v[104:107], v[24:27]
    s_waitcnt vmcnt(16)
    v_perm_b32 v16, v225, v225, s83
    v_and_b32 v28, v16, v8
    v_and_b32 v29, v16, v9
    v_and_b32 v30, v16, v10
    v_and_b32 v31, v16, v11
    s_nop 1
    v_mfma_f32_16x16x32_bf16 v[24:27], v[28:31], v[108:111], v[24:27]
    s_waitcnt vmcnt(15)
    v_perm_b32 v16, v226, v226, s82
    v_and_b32 v28, v16, v8
    v_and_b32 v29, v16, v9
    v_and_b32 v30, v16, v10
    v_and_b32 v31, v16, v11
    s_nop 1
    v_mfma_f32_16x16x32_bf16 v[24:27], v[28:31], v[112:115], v[24:27]
    s_waitcnt vmcnt(14)
    v_perm_b32 v16, v226, v226, s83
    v_and_b32 v28, v16, v8
    v_and_b32 v29, v16, v9
    v_and_b32 v30, v16, v10
    v_and_b32 v31, v16, v11
    s_nop 1
    v_mfma_f32_16x16x32_bf16 v[24:27], v[28:31], v[116:119], v[24:27]
    s_waitcnt vmcnt(13)
    v_perm_b32 v16, v227, v227, s82
    v_and_b32 v28, v16, v8
    v_and_b32 v29, v16, v9
    v_and_b32 v30, v16, v10
    v_and_b32 v31, v16, v11
    s_nop 1
    v_mfma_f32_16x16x32_bf16 v[24:27], v[28:31], v[120:123], v[24:27]
    s_waitcnt vmcnt(12)
    v_perm_b32 v16, v227, v227, s83
    v_and_b32 v28, v16, v8
    v_and_b32 v29, v16, v9
    v_and_b32 v30, v16, v10
    v_and_b32 v31, v16, v11
    s_nop 1
    v_mfma_f32_16x16x32_bf16 v[24:27], v[28:31], v[124:127], v[24:27]
    s_waitcnt vmcnt(11)
    v_perm_b32 v16, v228, v228, s82
    v_and_b32 v28, v16, v8
    v_and_b32 v29, v16, v9
    v_and_b32 v30, v16, v10
    v_and_b32 v31, v16, v11
    s_nop 1
    v_mfma_f32_16x16x32_bf16 v[24:27], v[28:31], v[128:131], v[24:27]
    s_waitcnt vmcnt(10)
    v_perm_b32 v16, v228, v228, s83
    v_and_b32 v28, v16, v8
    v_and_b32 v29, v16, v9
    v_and_b32 v30, v16, v10
    v_and_b32 v31, v16, v11
    s_nop 1
    v_mfma_f32_16x16x32_bf16 v[24:27], v[28:31], v[132:135], v[24:27]
    s_waitcnt vmcnt(9)
    v_perm_b32 v16, v229, v229, s82
    v_and_b32 v28, v16, v8
    v_and_b32 v29, v16, v9
    v_and_b32 v30, v16, v10
    v_and_b32 v31, v16, v11
    s_nop 1
    v_mfma_f32_16x16x32_bf16 v[24:27], v[28:31], v[136:139], v[24:27]
    s_waitcnt vmcnt(8)
    v_perm_b32 v16, v229, v229, s83
    v_and_b32 v28, v16, v8
    v_and_b32 v29, v16, v9
    v_and_b32 v30, v16, v10
    v_and_b32 v31, v16, v11
    s_nop 1
    v_mfma_f32_16x16x32_bf16 v[24:27], v[28:31], v[140:143], v[24:27]
    s_waitcnt vmcnt(7)
    v_perm_b32 v16, v230, v230, s82
    v_and_b32 v28, v16, v8
    v_and_b32 v29, v16, v9
    v_and_b32 v30, v16, v10
    v_and_b32 v31, v16, v11
    s_nop 1
    v_mfma_f32_16x16x32_bf16 v[24:27], v[28:31], v[144:147], v[24:27]
    s_waitcnt vmcnt(6)
    v_perm_b32 v16, v230, v230, s83
    v_and_b32 v28, v16, v8
    v_and_b32 v29, v16, v9
    v_and_b32 v30, v16, v10
    v_and_b32 v31, v16, v11
    s_nop 1
    v_mfma_f32_16x16x32_bf16 v[24:27], v[28:31], v[148:151], v[24:27]
    s_waitcnt vmcnt(5)
    v_perm_b32 v16, v231, v231, s82
    v_and_b32 v28, v16, v8
    v_and_b32 v29, v16, v9
    v_and_b32 v30, v16, v10
    v_and_b32 v31, v16, v11
    s_nop 1
    v_mfma_f32_16x16x32_bf16 v[24:27], v[28:31], v[152:155], v[24:27]
    s_waitcnt vmcnt(4)
    v_perm_b32 v16, v231, v231, s83
    v_and_b32 v28, v16, v8
    v_and_b32 v29, v16, v9
    v_and_b32 v30, v16, v10
    v_and_b32 v31, v16, v11
    s_nop 1
    v_mfma_f32_16x16x32_bf16 v[24:27], v[28:31], v[156:159], v[24:27]
    s_waitcnt vmcnt(3)
    v_perm_b32 v16, v232, v232, s82
    v_and_b32 v28, v16, v8
    v_and_b32 v29, v16, v9
    v_and_b32 v30, v16, v10
    v_and_b32 v31, v16, v11
    s_nop 1
    v_mfma_f32_16x16x32_bf16 v[24:27], v[28:31], v[160:163], v[24:27]
    s_waitcnt vmcnt(2)
    v_perm_b32 v16, v232, v232, s83
    v_and_b32 v28, v16, v8
    v_and_b32 v29, v16, v9
    v_and_b32 v30, v16, v10
    v_and_b32 v31, v16, v11
    s_nop 1
    v_mfma_f32_16x16x32_bf16 v[24:27], v[28:31], v[164:167], v[24:27]
    s_waitcnt vmcnt(1)
    v_perm_b32 v16, v233, v233, s82
    v_and_b32 v28, v16, v8
    v_and_b32 v29, v16, v9
    v_and_b32 v30, v16, v10
    v_and_b32 v31, v16, v11
    s_nop 1
    v_mfma_f32_16x16x32_bf16 v[24:27], v[28:31], v[168:171], v[24:27]
    s_waitcnt vmcnt(0)
    v_perm_b32 v16, v233, v233, s83
    v_and_b32 v28, v16, v8
    v_and_b32 v29, v16, v9
    v_and_b32 v30, v16, v10
    v_and_b32 v31, v16, v11
    s_nop 1
    v_mfma_f32_16x16x32_bf16 v[24:27], v[28:31], v[172:175], v[24:27]
    buffer_load_dwordx4 v[64:67], v5, s[24:27], s68 offen nt
    s_add_u32 s68, s68, 3584
    buffer_load_dwordx4 v[68:71], v5, s[24:27], s68 offen nt
    s_add_u32 s68, s68, 3584
    buffer_load_dwordx4 v[72:75], v5, s[24:27], s68 offen nt
    s_add_u32 s68, s68, 3584
    buffer_load_dwordx4 v[76:79], v5, s[24:27], s68 offen nt
    s_add_u32 s68, s68, 3584
    buffer_load_dwordx4 v[80:83], v5, s[24:27], s68 offen nt
    s_add_u32 s68, s68, 3584
    buffer_load_dwordx4 v[84:87], v5, s[24:27], s68 offen nt
    s_add_u32 s68, s68, 3584
    buffer_load_dwordx4 v[88:91], v5, s[24:27], s68 offen nt
    s_add_u32 s68, s68, 3584
    buffer_load_dwordx4 v[92:95], v5, s[24:27], s68 offen nt
    s_add_u32 s68, s68, 3584
    buffer_load_dwordx4 v[96:99], v5, s[24:27], s68 offen nt
    s_add_u32 s68, s68, 3584
    buffer_load_dwordx4 v[100:103], v5, s[24:27], s68 offen nt
    s_add_u32 s68, s68, 3584
    buffer_load_dwordx4 v[104:107], v5, s[24:27], s68 offen nt
    s_add_u32 s68, s68, 3584
    buffer_load_dwordx4 v[108:111], v5, s[24:27], s68 offen nt
    s_add_u32 s68, s68, 3584
    buffer_load_dwordx4 v[112:115], v5, s[24:27], s68 offen nt
    s_add_u32 s68, s68, 3584
    buffer_load_dwordx4 v[116:119], v5, s[24:27], s68 offen nt
    s_add_u32 s68, s68, 3584
    buffer_load_dwordx4 v[120:123], v5, s[24:27], s68 offen nt
    s_add_u32 s68, s68, 3584
    buffer_load_dwordx4 v[124:127], v5, s[24:27], s68 offen nt
    s_add_u32 s68, s68, 3584
    buffer_load_dwordx4 v[128:131], v5, s[24:27], s68 offen nt
    s_add_u32 s68, s68, 3584
    buffer_load_dwordx4 v[132:135], v5, s[24:27], s68 offen nt
    s_add_u32 s68, s68, 3584
    buffer_load_dwordx4 v[136:139], v5, s[24:27], s68 offen nt
    s_add_u32 s68, s68, 3584
    buffer_load_dwordx4 v[140:143], v5, s[24:27], s68 offen nt
    s_add_u32 s68, s68, 3584
    buffer_load_dwordx4 v[144:147], v5, s[24:27], s68 offen nt
    s_add_u32 s68, s68, 3584
    buffer_load_dwordx4 v[148:151], v5, s[24:27], s68 offen nt
    s_add_u32 s68, s68, 3584
    buffer_load_dwordx4 v[152:155], v5, s[24:27], s68 offen nt
    s_add_u32 s68, s68, 3584
    buffer_load_dwordx4 v[156:159], v5, s[24:27], s68 offen nt
    s_add_u32 s68, s68, 3584
    buffer_load_dwordx4 v[160:163], v5, s[24:27], s68 offen nt
    s_add_u32 s68, s68, 3584
    buffer_load_dwordx4 v[164:167], v5, s[24:27], s68 offen nt
    s_add_u32 s68, s68, 3584
    buffer_load_dwordx4 v[168:171], v5, s[24:27], s68 offen nt
    s_add_u32 s68, s68, 3584
    buffer_load_dwordx4 v[172:175], v5, s[24:27], s68 offen nt
    s_add_u32 s68, s68, 3584
    s_waitcnt vmcnt(27)
    v_perm_b32 v16, v234, v234, s82
    v_and_b32 v28, v16, v8
    v_and_b32 v29, v16, v9
    v_and_b32 v30, v16, v10
    v_and_b32 v31, v16, v11
    s_nop 1
    v_mfma_f32_16x16x32_bf16 v[24:27], v[28:31], v[64:67], v[24:27]
    s_waitcnt vmcnt(26)
    v_perm_b32 v16, v234, v234, s83
    v_and_b32 v28, v16, v8
    v_and_b32 v29, v16, v9
    v_and_b32 v30, v16, v10
    v_and_b32 v31, v16, v11
    s_nop 1
    v_mfma_f32_16x16x32_bf16 v[24:27], v[28:31], v[68:71], v[24:27]
    s_waitcnt vmcnt(25)
    v_perm_b32 v16, v235, v235, s82
    v_and_b32 v28, v16, v8
    v_and_b32 v29, v16, v9
    v_and_b32 v30, v16, v10
    v_and_b32 v31, v16, v11
    s_nop 1
    v_mfma_f32_16x16x32_bf16 v[24:27], v[28:31], v[72:75], v[24:27]
    s_waitcnt vmcnt(24)
    v_perm_b32 v16, v235, v235, s83
    v_and_b32 v28, v16, v8
    v_and_b32 v29, v16, v9
    v_and_b32 v30, v16, v10
    v_and_b32 v31, v16, v11
    s_nop 1
    v_mfma_f32_16x16x32_bf16 v[24:27], v[28:31], v[76:79], v[24:27]
    s_waitcnt vmcnt(23)
    v_perm_b32 v16, v236, v236, s82
    v_and_b32 v28, v16, v8
    v_and_b32 v29, v16, v9
    v_and_b32 v30, v16, v10
    v_and_b32 v31, v16, v11
    s_nop 1
    v_mfma_f32_16x16x32_bf16 v[24:27], v[28:31], v[80:83], v[24:27]
    s_waitcnt vmcnt(22)
    v_perm_b32 v16, v236, v236, s83
    v_and_b32 v28, v16, v8
    v_and_b32 v29, v16, v9
    v_and_b32 v30, v16, v10
    v_and_b32 v31, v16, v11
    s_nop 1
    v_mfma_f32_16x16x32_bf16 v[24:27], v[28:31], v[84:87], v[24:27]
    s_waitcnt vmcnt(21)
    v_perm_b32 v16, v237, v237, s82
    v_and_b32 v28, v16, v8
    v_and_b32 v29, v16, v9
    v_and_b32 v30, v16, v10
    v_and_b32 v31, v16, v11
    s_nop 1
    v_mfma_f32_16x16x32_bf16 v[24:27], v[28:31], v[88:91], v[24:27]
    s_waitcnt vmcnt(20)
    v_perm_b32 v16, v237, v237, s83
    v_and_b32 v28, v16, v8
    v_and_b32 v29, v16, v9
    v_and_b32 v30, v16, v10
    v_and_b32 v31, v16, v11
    s_nop 1
    v_mfma_f32_16x16x32_bf16 v[24:27], v[28:31], v[92:95], v[24:27]
    s_waitcnt vmcnt(19)
    v_perm_b32 v16, v238, v238, s82
    v_and_b32 v28, v16, v8
    v_and_b32 v29, v16, v9
    v_and_b32 v30, v16, v10
    v_and_b32 v31, v16, v11
    s_nop 1
    v_mfma_f32_16x16x32_bf16 v[24:27], v[28:31], v[96:99], v[24:27]
    s_waitcnt vmcnt(18)
    v_perm_b32 v16, v238, v238, s83
    v_and_b32 v28, v16, v8
    v_and_b32 v29, v16, v9
    v_and_b32 v30, v16, v10
    v_and_b32 v31, v16, v11
    s_nop 1
    v_mfma_f32_16x16x32_bf16 v[24:27], v[28:31], v[100:103], v[24:27]
    s_waitcnt vmcnt(17)
    v_perm_b32 v16, v239, v239, s82
    v_and_b32 v28, v16, v8
    v_and_b32 v29, v16, v9
    v_and_b32 v30, v16, v10
    v_and_b32 v31, v16, v11
    s_nop 1
    v_mfma_f32_16x16x32_bf16 v[24:27], v[28:31], v[104:107], v[24:27]
    s_waitcnt vmcnt(16)
    v_perm_b32 v16, v239, v239, s83
    v_and_b32 v28, v16, v8
    v_and_b32 v29, v16, v9
    v_and_b32 v30, v16, v10
    v_and_b32 v31, v16, v11
    s_nop 1
    v_mfma_f32_16x16x32_bf16 v[24:27], v[28:31], v[108:111], v[24:27]
    s_waitcnt vmcnt(15)
    v_perm_b32 v16, v240, v240, s82
    v_and_b32 v28, v16, v8
    v_and_b32 v29, v16, v9
    v_and_b32 v30, v16, v10
    v_and_b32 v31, v16, v11
    s_nop 1
    v_mfma_f32_16x16x32_bf16 v[24:27], v[28:31], v[112:115], v[24:27]
    s_waitcnt vmcnt(14)
    v_perm_b32 v16, v240, v240, s83
    v_and_b32 v28, v16, v8
    v_and_b32 v29, v16, v9
    v_and_b32 v30, v16, v10
    v_and_b32 v31, v16, v11
    s_nop 1
    v_mfma_f32_16x16x32_bf16 v[24:27], v[28:31], v[116:119], v[24:27]
    s_waitcnt vmcnt(13)
    v_perm_b32 v16, v241, v241, s82
    v_and_b32 v28, v16, v8
    v_and_b32 v29, v16, v9
    v_and_b32 v30, v16, v10
    v_and_b32 v31, v16, v11
    s_nop 1
    v_mfma_f32_16x16x32_bf16 v[24:27], v[28:31], v[120:123], v[24:27]
    s_waitcnt vmcnt(12)
    v_perm_b32 v16, v241, v241, s83
    v_and_b32 v28, v16, v8
    v_and_b32 v29, v16, v9
    v_and_b32 v30, v16, v10
    v_and_b32 v31, v16, v11
    s_nop 1
    v_mfma_f32_16x16x32_bf16 v[24:27], v[28:31], v[124:127], v[24:27]
    s_waitcnt vmcnt(11)
    v_perm_b32 v16, v242, v242, s82
    v_and_b32 v28, v16, v8
    v_and_b32 v29, v16, v9
    v_and_b32 v30, v16, v10
    v_and_b32 v31, v16, v11
    s_nop 1
    v_mfma_f32_16x16x32_bf16 v[24:27], v[28:31], v[128:131], v[24:27]
    s_waitcnt vmcnt(10)
    v_perm_b32 v16, v242, v242, s83
    v_and_b32 v28, v16, v8
    v_and_b32 v29, v16, v9
    v_and_b32 v30, v16, v10
    v_and_b32 v31, v16, v11
    s_nop 1
    v_mfma_f32_16x16x32_bf16 v[24:27], v[28:31], v[132:135], v[24:27]
    s_waitcnt vmcnt(9)
    v_perm_b32 v16, v243, v243, s82
    v_and_b32 v28, v16, v8
    v_and_b32 v29, v16, v9
    v_and_b32 v30, v16, v10
    v_and_b32 v31, v16, v11
    s_nop 1
    v_mfma_f32_16x16x32_bf16 v[24:27], v[28:31], v[136:139], v[24:27]
    s_waitcnt vmcnt(8)
    v_perm_b32 v16, v243, v243, s83
    v_and_b32 v28, v16, v8
    v_and_b32 v29, v16, v9
    v_and_b32 v30, v16, v10
    v_and_b32 v31, v16, v11
    s_nop 1
    v_mfma_f32_16x16x32_bf16 v[24:27], v[28:31], v[140:143], v[24:27]
    s_waitcnt vmcnt(7)
    v_perm_b32 v16, v244, v244, s82
    v_and_b32 v28, v16, v8
    v_and_b32 v29, v16, v9
    v_and_b32 v30, v16, v10
    v_and_b32 v31, v16, v11
    s_nop 1
    v_mfma_f32_16x16x32_bf16 v[24:27], v[28:31], v[144:147], v[24:27]
    s_waitcnt vmcnt(6)
    v_perm_b32 v16, v244, v244, s83
    v_and_b32 v28, v16, v8
    v_and_b32 v29, v16, v9
    v_and_b32 v30, v16, v10
    v_and_b32 v31, v16, v11
    s_nop 1
    v_mfma_f32_16x16x32_bf16 v[24:27], v[28:31], v[148:151], v[24:27]
    s_waitcnt vmcnt(5)
    v_perm_b32 v16, v245, v245, s82
    v_and_b32 v28, v16, v8
    v_and_b32 v29, v16, v9
    v_and_b32 v30, v16, v10
    v_and_b32 v31, v16, v11
    s_nop 1
    v_mfma_f32_16x16x32_bf16 v[24:27], v[28:31], v[152:155], v[24:27]
    s_waitcnt vmcnt(4)
    v_perm_b32 v16, v245, v245, s83
    v_and_b32 v28, v16, v8
    v_and_b32 v29, v16, v9
    v_and_b32 v30, v16, v10
    v_and_b32 v31, v16, v11
    s_nop 1
    v_mfma_f32_16x16x32_bf16 v[24:27], v[28:31], v[156:159], v[24:27]
    s_waitcnt vmcnt(3)
    v_perm_b32 v16, v246, v246, s82
    v_and_b32 v28, v16, v8
    v_and_b32 v29, v16, v9
    v_and_b32 v30, v16, v10
    v_and_b32 v31, v16, v11
    s_nop 1
    v_mfma_f32_16x16x32_bf16 v[24:27], v[28:31], v[160:163], v[24:27]
    s_waitcnt vmcnt(2)
    v_perm_b32 v16, v246, v246, s83
    v_and_b32 v28, v16, v8
    v_and_b32 v29, v16, v9
    v_and_b32 v30, v16, v10
    v_and_b32 v31, v16, v11
    s_nop 1
    v_mfma_f32_16x16x32_bf16 v[24:27], v[28:31], v[164:167], v[24:27]
    s_waitcnt vmcnt(1)
    v_perm_b32 v16, v247, v247, s82
    v_and_b32 v28, v16, v8
    v_and_b32 v29, v16, v9
    v_and_b32 v30, v16, v10
    v_and_b32 v31, v16, v11
    s_nop 1
    v_mfma_f32_16x16x32_bf16 v[24:27], v[28:31], v[168:171], v[24:27]
    s_waitcnt vmcnt(0)
    v_perm_b32 v16, v247, v247, s83
    v_and_b32 v28, v16, v8
    v_and_b32 v29, v16, v9
    v_and_b32 v30, v16, v10
    v_and_b32 v31, v16, v11
    s_nop 1
    v_mfma_f32_16x16x32_bf16 v[24:27], v[28:31], v[172:175], v[24:27]
    s_nop 7
    v_mov_b32 v25, v26
    v_cvt_pk_bf16_f32 v24, v24, v24
    v_and_b32 v24, 0xffff0000, v24
    v_cvt_pk_bf16_f32 v25, v25, v25
    v_and_b32 v25, 0xffff0000, v25
    v_lshlrev_b32 v26, 16, v248
    v_and_b32 v27, 0xffff0000, v248
    v_add_f32 v24, v24, v26
    v_add_f32 v25, v25, v27
    v_cvt_pk_bf16_f32 v24, v24, v24
    v_and_b32 v24, 0xffff0000, v24
    v_cvt_pk_bf16_f32 v25, v25, v25
    v_and_b32 v25, 0xffff0000, v25
    s_mov_b32 s69, 0x3d372713
    s_mov_b32 s70, 0xc0135761
    v_mul_f32 v26, v24, v24
    v_mul_f32 v26, v26, v24
    v_fma_f32 v26, v26, s69, v24
    v_mul_f32 v26, s70, v26
    v_exp_f32 v26, v26
    s_nop 0
    v_add_f32 v26, 1.0, v26
    v_rcp_f32 v26, v26
    s_nop 0
    v_mul_f32 v24, v24, v26
    v_mul_f32 v26, v25, v25
    v_mul_f32 v26, v26, v25
    v_fma_f32 v26, v26, s69, v25
    v_mul_f32 v26, s70, v26
    v_exp_f32 v26, v26
    s_nop 0
    v_add_f32 v26, 1.0, v26
    v_rcp_f32 v26, v26
    s_nop 0
    v_mul_f32 v25, v25, v26
    v_cvt_pk_bf16_f32 v24, v24, v25
    ds_write_b32 v6, v24 offset:5376
    v_lshlrev_b32 v4, 6, v13
    s_waitcnt lgkmcnt(0)
    ds_read_b128 v[32:35], v4 offset:5376
    ds_read_b128 v[36:39], v4 offset:5392
    ds_read_b128 v[40:43], v4 offset:5408
    ds_read_b128 v[44:47], v4 offset:5424
    s_mov_b32 s24, s48
    s_mov_b32 s25, s49
    s_mov_b32 s26, 1605632
    s_mov_b32 s27, 0x20000
    s_mov_b32 s68, 28672
    v_mul_lo_u32 v5, v13, s68
    v_lshl_add_u32 v5, v12, 4, v5
    s_mul_i32 s68, s65, 114688
    s_waitcnt lgkmcnt(0)
    buffer_load_dwordx4 v[64:67], v5, s[24:27], s68 offen offset:0 nt
    buffer_load_dwordx4 v[68:71], v5, s[24:27], s68 offen offset:256 nt
    buffer_load_dwordx4 v[72:75], v5, s[24:27], s68 offen offset:512 nt
    s_mov_b32 exec_lo, 0x00ff00ff
    s_mov_b32 exec_hi, 0x00ff00ff
    buffer_load_dwordx4 v[76:79], v5, s[24:27], s68 offen offset:768 nt
    s_mov_b64 exec, -1
    s_add_u32 s68, s68, 896
    buffer_load_dwordx4 v[80:83], v5, s[24:27], s68 offen offset:0 nt
    buffer_load_dwordx4 v[84:87], v5, s[24:27], s68 offen offset:256 nt
    buffer_load_dwordx4 v[88:91], v5, s[24:27], s68 offen offset:512 nt
    s_mov_b32 exec_lo, 0x00ff00ff
    s_mov_b32 exec_hi, 0x00ff00ff
    buffer_load_dwordx4 v[92:95], v5, s[24:27], s68 offen offset:768 nt
    s_mov_b64 exec, -1
    s_add_u32 s68, s68, 896
    buffer_load_dwordx4 v[96:99], v5, s[24:27], s68 offen offset:0 nt
    buffer_load_dwordx4 v[100:103], v5, s[24:27], s68 offen offset:256 nt
    buffer_load_dwordx4 v[104:107], v5, s[24:27], s68 offen offset:512 nt
    s_mov_b32 exec_lo, 0x00ff00ff
    s_mov_b32 exec_hi, 0x00ff00ff
    buffer_load_dwordx4 v[108:111], v5, s[24:27], s68 offen offset:768 nt
    s_mov_b64 exec, -1
    s_add_u32 s68, s68, 896
    buffer_load_dwordx4 v[112:115], v5, s[24:27], s68 offen offset:0 nt
    buffer_load_dwordx4 v[116:119], v5, s[24:27], s68 offen offset:256 nt
    buffer_load_dwordx4 v[120:123], v5, s[24:27], s68 offen offset:512 nt
    s_mov_b32 exec_lo, 0x00ff00ff
    s_mov_b32 exec_hi, 0x00ff00ff
    buffer_load_dwordx4 v[124:127], v5, s[24:27], s68 offen offset:768 nt
    s_mov_b64 exec, -1
    s_add_u32 s68, s68, 896
    buffer_load_dwordx4 v[128:131], v5, s[24:27], s68 offen offset:0 nt
    buffer_load_dwordx4 v[132:135], v5, s[24:27], s68 offen offset:256 nt
    buffer_load_dwordx4 v[136:139], v5, s[24:27], s68 offen offset:512 nt
    s_mov_b32 exec_lo, 0x00ff00ff
    s_mov_b32 exec_hi, 0x00ff00ff
    buffer_load_dwordx4 v[140:143], v5, s[24:27], s68 offen offset:768 nt
    s_mov_b64 exec, -1
    s_add_u32 s68, s68, 896
    buffer_load_dwordx4 v[144:147], v5, s[24:27], s68 offen offset:0 nt
    buffer_load_dwordx4 v[148:151], v5, s[24:27], s68 offen offset:256 nt
    buffer_load_dwordx4 v[152:155], v5, s[24:27], s68 offen offset:512 nt
    s_mov_b32 exec_lo, 0x00ff00ff
    s_mov_b32 exec_hi, 0x00ff00ff
    buffer_load_dwordx4 v[156:159], v5, s[24:27], s68 offen offset:768 nt
    s_mov_b64 exec, -1
    s_add_u32 s68, s68, 896
    buffer_load_dwordx4 v[160:163], v5, s[24:27], s68 offen offset:0 nt
    buffer_load_dwordx4 v[164:167], v5, s[24:27], s68 offen offset:256 nt
    buffer_load_dwordx4 v[168:171], v5, s[24:27], s68 offen offset:512 nt
    s_mov_b32 exec_lo, 0x00ff00ff
    s_mov_b32 exec_hi, 0x00ff00ff
    buffer_load_dwordx4 v[172:175], v5, s[24:27], s68 offen offset:768 nt
    s_mov_b64 exec, -1
    s_add_u32 s68, s68, 896
    buffer_load_dwordx4 v[176:179], v5, s[24:27], s68 offen offset:0 nt
    buffer_load_dwordx4 v[180:183], v5, s[24:27], s68 offen offset:256 nt
    buffer_load_dwordx4 v[184:187], v5, s[24:27], s68 offen offset:512 nt
    s_mov_b32 exec_lo, 0x00ff00ff
    s_mov_b32 exec_hi, 0x00ff00ff
    buffer_load_dwordx4 v[188:191], v5, s[24:27], s68 offen offset:768 nt
    s_mov_b64 exec, -1
    s_add_u32 s68, s68, 896
    s_waitcnt vmcnt(28)
    v_perm_b32 v16, v32, v32, s82
    v_and_b32 v28, v16, v8
    v_and_b32 v29, v16, v9
    v_and_b32 v30, v16, v10
    v_and_b32 v31, v16, v11
    s_nop 1
    v_mfma_f32_16x16x32_bf16 v[48:51], v[28:31], v[64:67], 0
    v_mfma_f32_16x16x32_bf16 v[52:55], v[28:31], v[68:71], 0
    v_mfma_f32_16x16x32_bf16 v[56:59], v[28:31], v[72:75], 0
    v_mfma_f32_16x16x32_bf16 v[60:63], v[28:31], v[76:79], 0
    s_waitcnt vmcnt(24)
    v_perm_b32 v16, v32, v32, s83
    v_and_b32 v28, v16, v8
    v_and_b32 v29, v16, v9
    v_and_b32 v30, v16, v10
    v_and_b32 v31, v16, v11
    s_nop 1
    v_mfma_f32_16x16x32_bf16 v[48:51], v[28:31], v[80:83], v[48:51]
    v_mfma_f32_16x16x32_bf16 v[52:55], v[28:31], v[84:87], v[52:55]
    v_mfma_f32_16x16x32_bf16 v[56:59], v[28:31], v[88:91], v[56:59]
    v_mfma_f32_16x16x32_bf16 v[60:63], v[28:31], v[92:95], v[60:63]
    s_waitcnt vmcnt(20)
    v_perm_b32 v16, v33, v33, s82
    v_and_b32 v28, v16, v8
    v_and_b32 v29, v16, v9
    v_and_b32 v30, v16, v10
    v_and_b32 v31, v16, v11
    s_nop 1
    v_mfma_f32_16x16x32_bf16 v[48:51], v[28:31], v[96:99], v[48:51]
    v_mfma_f32_16x16x32_bf16 v[52:55], v[28:31], v[100:103], v[52:55]
    v_mfma_f32_16x16x32_bf16 v[56:59], v[28:31], v[104:107], v[56:59]
    v_mfma_f32_16x16x32_bf16 v[60:63], v[28:31], v[108:111], v[60:63]
    s_waitcnt vmcnt(16)
    v_perm_b32 v16, v33, v33, s83
    v_and_b32 v28, v16, v8
    v_and_b32 v29, v16, v9
    v_and_b32 v30, v16, v10
    v_and_b32 v31, v16, v11
    s_nop 1
    v_mfma_f32_16x16x32_bf16 v[48:51], v[28:31], v[112:115], v[48:51]
    v_mfma_f32_16x16x32_bf16 v[52:55], v[28:31], v[116:119], v[52:55]
    v_mfma_f32_16x16x32_bf16 v[56:59], v[28:31], v[120:123], v[56:59]
    v_mfma_f32_16x16x32_bf16 v[60:63], v[28:31], v[124:127], v[60:63]
    s_waitcnt vmcnt(12)
    v_perm_b32 v16, v34, v34, s82
    v_and_b32 v28, v16, v8
    v_and_b32 v29, v16, v9
    v_and_b32 v30, v16, v10
    v_and_b32 v31, v16, v11
    s_nop 1
    v_mfma_f32_16x16x32_bf16 v[48:51], v[28:31], v[128:131], v[48:51]
    v_mfma_f32_16x16x32_bf16 v[52:55], v[28:31], v[132:135], v[52:55]
    v_mfma_f32_16x16x32_bf16 v[56:59], v[28:31], v[136:139], v[56:59]
    v_mfma_f32_16x16x32_bf16 v[60:63], v[28:31], v[140:143], v[60:63]
    s_waitcnt vmcnt(8)
    v_perm_b32 v16, v34, v34, s83
    v_and_b32 v28, v16, v8
    v_and_b32 v29, v16, v9
    v_and_b32 v30, v16, v10
    v_and_b32 v31, v16, v11
    s_nop 1
    v_mfma_f32_16x16x32_bf16 v[48:51], v[28:31], v[144:147], v[48:51]
    v_mfma_f32_16x16x32_bf16 v[52:55], v[28:31], v[148:151], v[52:55]
    v_mfma_f32_16x16x32_bf16 v[56:59], v[28:31], v[152:155], v[56:59]
    v_mfma_f32_16x16x32_bf16 v[60:63], v[28:31], v[156:159], v[60:63]
    s_waitcnt vmcnt(4)
    v_perm_b32 v16, v35, v35, s82
    v_and_b32 v28, v16, v8
    v_and_b32 v29, v16, v9
    v_and_b32 v30, v16, v10
    v_and_b32 v31, v16, v11
    s_nop 1
    v_mfma_f32_16x16x32_bf16 v[48:51], v[28:31], v[160:163], v[48:51]
    v_mfma_f32_16x16x32_bf16 v[52:55], v[28:31], v[164:167], v[52:55]
    v_mfma_f32_16x16x32_bf16 v[56:59], v[28:31], v[168:171], v[56:59]
    v_mfma_f32_16x16x32_bf16 v[60:63], v[28:31], v[172:175], v[60:63]
    s_waitcnt vmcnt(0)
    v_perm_b32 v16, v35, v35, s83
    v_and_b32 v28, v16, v8
    v_and_b32 v29, v16, v9
    v_and_b32 v30, v16, v10
    v_and_b32 v31, v16, v11
    s_nop 1
    v_mfma_f32_16x16x32_bf16 v[48:51], v[28:31], v[176:179], v[48:51]
    v_mfma_f32_16x16x32_bf16 v[52:55], v[28:31], v[180:183], v[52:55]
    v_mfma_f32_16x16x32_bf16 v[56:59], v[28:31], v[184:187], v[56:59]
    v_mfma_f32_16x16x32_bf16 v[60:63], v[28:31], v[188:191], v[60:63]
    buffer_load_dwordx4 v[64:67], v5, s[24:27], s68 offen offset:0 nt
    buffer_load_dwordx4 v[68:71], v5, s[24:27], s68 offen offset:256 nt
    buffer_load_dwordx4 v[72:75], v5, s[24:27], s68 offen offset:512 nt
    s_mov_b32 exec_lo, 0x00ff00ff
    s_mov_b32 exec_hi, 0x00ff00ff
    buffer_load_dwordx4 v[76:79], v5, s[24:27], s68 offen offset:768 nt
    s_mov_b64 exec, -1
    s_add_u32 s68, s68, 896
    buffer_load_dwordx4 v[80:83], v5, s[24:27], s68 offen offset:0 nt
    buffer_load_dwordx4 v[84:87], v5, s[24:27], s68 offen offset:256 nt
    buffer_load_dwordx4 v[88:91], v5, s[24:27], s68 offen offset:512 nt
    s_mov_b32 exec_lo, 0x00ff00ff
    s_mov_b32 exec_hi, 0x00ff00ff
    buffer_load_dwordx4 v[92:95], v5, s[24:27], s68 offen offset:768 nt
    s_mov_b64 exec, -1
    s_add_u32 s68, s68, 896
    buffer_load_dwordx4 v[96:99], v5, s[24:27], s68 offen offset:0 nt
    buffer_load_dwordx4 v[100:103], v5, s[24:27], s68 offen offset:256 nt
    buffer_load_dwordx4 v[104:107], v5, s[24:27], s68 offen offset:512 nt
    s_mov_b32 exec_lo, 0x00ff00ff
    s_mov_b32 exec_hi, 0x00ff00ff
    buffer_load_dwordx4 v[108:111], v5, s[24:27], s68 offen offset:768 nt
    s_mov_b64 exec, -1
    s_add_u32 s68, s68, 896
    buffer_load_dwordx4 v[112:115], v5, s[24:27], s68 offen offset:0 nt
    buffer_load_dwordx4 v[116:119], v5, s[24:27], s68 offen offset:256 nt
    buffer_load_dwordx4 v[120:123], v5, s[24:27], s68 offen offset:512 nt
    s_mov_b32 exec_lo, 0x00ff00ff
    s_mov_b32 exec_hi, 0x00ff00ff
    buffer_load_dwordx4 v[124:127], v5, s[24:27], s68 offen offset:768 nt
    s_mov_b64 exec, -1
    s_add_u32 s68, s68, 896
    buffer_load_dwordx4 v[128:131], v5, s[24:27], s68 offen offset:0 nt
    buffer_load_dwordx4 v[132:135], v5, s[24:27], s68 offen offset:256 nt
    buffer_load_dwordx4 v[136:139], v5, s[24:27], s68 offen offset:512 nt
    s_mov_b32 exec_lo, 0x00ff00ff
    s_mov_b32 exec_hi, 0x00ff00ff
    buffer_load_dwordx4 v[140:143], v5, s[24:27], s68 offen offset:768 nt
    s_mov_b64 exec, -1
    s_add_u32 s68, s68, 896
    buffer_load_dwordx4 v[144:147], v5, s[24:27], s68 offen offset:0 nt
    buffer_load_dwordx4 v[148:151], v5, s[24:27], s68 offen offset:256 nt
    buffer_load_dwordx4 v[152:155], v5, s[24:27], s68 offen offset:512 nt
    s_mov_b32 exec_lo, 0x00ff00ff
    s_mov_b32 exec_hi, 0x00ff00ff
    buffer_load_dwordx4 v[156:159], v5, s[24:27], s68 offen offset:768 nt
    s_mov_b64 exec, -1
    s_add_u32 s68, s68, 896
    buffer_load_dwordx4 v[160:163], v5, s[24:27], s68 offen offset:0 nt
    buffer_load_dwordx4 v[164:167], v5, s[24:27], s68 offen offset:256 nt
    buffer_load_dwordx4 v[168:171], v5, s[24:27], s68 offen offset:512 nt
    s_mov_b32 exec_lo, 0x00ff00ff
    s_mov_b32 exec_hi, 0x00ff00ff
    buffer_load_dwordx4 v[172:175], v5, s[24:27], s68 offen offset:768 nt
    s_mov_b64 exec, -1
    s_add_u32 s68, s68, 896
    buffer_load_dwordx4 v[176:179], v5, s[24:27], s68 offen offset:0 nt
    buffer_load_dwordx4 v[180:183], v5, s[24:27], s68 offen offset:256 nt
    buffer_load_dwordx4 v[184:187], v5, s[24:27], s68 offen offset:512 nt
    s_mov_b32 exec_lo, 0x00ff00ff
    s_mov_b32 exec_hi, 0x00ff00ff
    buffer_load_dwordx4 v[188:191], v5, s[24:27], s68 offen offset:768 nt
    s_mov_b64 exec, -1
    s_add_u32 s68, s68, 896
    s_waitcnt vmcnt(28)
    v_perm_b32 v16, v36, v36, s82
    v_and_b32 v28, v16, v8
    v_and_b32 v29, v16, v9
    v_and_b32 v30, v16, v10
    v_and_b32 v31, v16, v11
    s_nop 1
    v_mfma_f32_16x16x32_bf16 v[48:51], v[28:31], v[64:67], v[48:51]
    v_mfma_f32_16x16x32_bf16 v[52:55], v[28:31], v[68:71], v[52:55]
    v_mfma_f32_16x16x32_bf16 v[56:59], v[28:31], v[72:75], v[56:59]
    v_mfma_f32_16x16x32_bf16 v[60:63], v[28:31], v[76:79], v[60:63]
    s_waitcnt vmcnt(24)
    v_perm_b32 v16, v36, v36, s83
    v_and_b32 v28, v16, v8
    v_and_b32 v29, v16, v9
    v_and_b32 v30, v16, v10
    v_and_b32 v31, v16, v11
    s_nop 1
    v_mfma_f32_16x16x32_bf16 v[48:51], v[28:31], v[80:83], v[48:51]
    v_mfma_f32_16x16x32_bf16 v[52:55], v[28:31], v[84:87], v[52:55]
    v_mfma_f32_16x16x32_bf16 v[56:59], v[28:31], v[88:91], v[56:59]
    v_mfma_f32_16x16x32_bf16 v[60:63], v[28:31], v[92:95], v[60:63]
    s_waitcnt vmcnt(20)
    v_perm_b32 v16, v37, v37, s82
    v_and_b32 v28, v16, v8
    v_and_b32 v29, v16, v9
    v_and_b32 v30, v16, v10
    v_and_b32 v31, v16, v11
    s_nop 1
    v_mfma_f32_16x16x32_bf16 v[48:51], v[28:31], v[96:99], v[48:51]
    v_mfma_f32_16x16x32_bf16 v[52:55], v[28:31], v[100:103], v[52:55]
    v_mfma_f32_16x16x32_bf16 v[56:59], v[28:31], v[104:107], v[56:59]
    v_mfma_f32_16x16x32_bf16 v[60:63], v[28:31], v[108:111], v[60:63]
    s_waitcnt vmcnt(16)
    v_perm_b32 v16, v37, v37, s83
    v_and_b32 v28, v16, v8
    v_and_b32 v29, v16, v9
    v_and_b32 v30, v16, v10
    v_and_b32 v31, v16, v11
    s_nop 1
    v_mfma_f32_16x16x32_bf16 v[48:51], v[28:31], v[112:115], v[48:51]
    v_mfma_f32_16x16x32_bf16 v[52:55], v[28:31], v[116:119], v[52:55]
    v_mfma_f32_16x16x32_bf16 v[56:59], v[28:31], v[120:123], v[56:59]
    v_mfma_f32_16x16x32_bf16 v[60:63], v[28:31], v[124:127], v[60:63]
    s_waitcnt vmcnt(12)
    v_perm_b32 v16, v38, v38, s82
    v_and_b32 v28, v16, v8
    v_and_b32 v29, v16, v9
    v_and_b32 v30, v16, v10
    v_and_b32 v31, v16, v11
    s_nop 1
    v_mfma_f32_16x16x32_bf16 v[48:51], v[28:31], v[128:131], v[48:51]
    v_mfma_f32_16x16x32_bf16 v[52:55], v[28:31], v[132:135], v[52:55]
    v_mfma_f32_16x16x32_bf16 v[56:59], v[28:31], v[136:139], v[56:59]
    v_mfma_f32_16x16x32_bf16 v[60:63], v[28:31], v[140:143], v[60:63]
    s_waitcnt vmcnt(8)
    v_perm_b32 v16, v38, v38, s83
    v_and_b32 v28, v16, v8
    v_and_b32 v29, v16, v9
    v_and_b32 v30, v16, v10
    v_and_b32 v31, v16, v11
    s_nop 1
    v_mfma_f32_16x16x32_bf16 v[48:51], v[28:31], v[144:147], v[48:51]
    v_mfma_f32_16x16x32_bf16 v[52:55], v[28:31], v[148:151], v[52:55]
    v_mfma_f32_16x16x32_bf16 v[56:59], v[28:31], v[152:155], v[56:59]
    v_mfma_f32_16x16x32_bf16 v[60:63], v[28:31], v[156:159], v[60:63]
    s_waitcnt vmcnt(4)
    v_perm_b32 v16, v39, v39, s82
    v_and_b32 v28, v16, v8
    v_and_b32 v29, v16, v9
    v_and_b32 v30, v16, v10
    v_and_b32 v31, v16, v11
    s_nop 1
    v_mfma_f32_16x16x32_bf16 v[48:51], v[28:31], v[160:163], v[48:51]
    v_mfma_f32_16x16x32_bf16 v[52:55], v[28:31], v[164:167], v[52:55]
    v_mfma_f32_16x16x32_bf16 v[56:59], v[28:31], v[168:171], v[56:59]
    v_mfma_f32_16x16x32_bf16 v[60:63], v[28:31], v[172:175], v[60:63]
    s_waitcnt vmcnt(0)
    v_perm_b32 v16, v39, v39, s83
    v_and_b32 v28, v16, v8
    v_and_b32 v29, v16, v9
    v_and_b32 v30, v16, v10
    v_and_b32 v31, v16, v11
    s_nop 1
    v_mfma_f32_16x16x32_bf16 v[48:51], v[28:31], v[176:179], v[48:51]
    v_mfma_f32_16x16x32_bf16 v[52:55], v[28:31], v[180:183], v[52:55]
    v_mfma_f32_16x16x32_bf16 v[56:59], v[28:31], v[184:187], v[56:59]
    v_mfma_f32_16x16x32_bf16 v[60:63], v[28:31], v[188:191], v[60:63]
    buffer_load_dwordx4 v[64:67], v5, s[24:27], s68 offen offset:0 nt
    buffer_load_dwordx4 v[68:71], v5, s[24:27], s68 offen offset:256 nt
    buffer_load_dwordx4 v[72:75], v5, s[24:27], s68 offen offset:512 nt
    s_mov_b32 exec_lo, 0x00ff00ff
    s_mov_b32 exec_hi, 0x00ff00ff
    buffer_load_dwordx4 v[76:79], v5, s[24:27], s68 offen offset:768 nt
    s_mov_b64 exec, -1
    s_add_u32 s68, s68, 896
    buffer_load_dwordx4 v[80:83], v5, s[24:27], s68 offen offset:0 nt
    buffer_load_dwordx4 v[84:87], v5, s[24:27], s68 offen offset:256 nt
    buffer_load_dwordx4 v[88:91], v5, s[24:27], s68 offen offset:512 nt
    s_mov_b32 exec_lo, 0x00ff00ff
    s_mov_b32 exec_hi, 0x00ff00ff
    buffer_load_dwordx4 v[92:95], v5, s[24:27], s68 offen offset:768 nt
    s_mov_b64 exec, -1
    s_add_u32 s68, s68, 896
    buffer_load_dwordx4 v[96:99], v5, s[24:27], s68 offen offset:0 nt
    buffer_load_dwordx4 v[100:103], v5, s[24:27], s68 offen offset:256 nt
    buffer_load_dwordx4 v[104:107], v5, s[24:27], s68 offen offset:512 nt
    s_mov_b32 exec_lo, 0x00ff00ff
    s_mov_b32 exec_hi, 0x00ff00ff
    buffer_load_dwordx4 v[108:111], v5, s[24:27], s68 offen offset:768 nt
    s_mov_b64 exec, -1
    s_add_u32 s68, s68, 896
    buffer_load_dwordx4 v[112:115], v5, s[24:27], s68 offen offset:0 nt
    buffer_load_dwordx4 v[116:119], v5, s[24:27], s68 offen offset:256 nt
    buffer_load_dwordx4 v[120:123], v5, s[24:27], s68 offen offset:512 nt
    s_mov_b32 exec_lo, 0x00ff00ff
    s_mov_b32 exec_hi, 0x00ff00ff
    buffer_load_dwordx4 v[124:127], v5, s[24:27], s68 offen offset:768 nt
    s_mov_b64 exec, -1
    s_add_u32 s68, s68, 896
    buffer_load_dwordx4 v[128:131], v5, s[24:27], s68 offen offset:0 nt
    buffer_load_dwordx4 v[132:135], v5, s[24:27], s68 offen offset:256 nt
    buffer_load_dwordx4 v[136:139], v5, s[24:27], s68 offen offset:512 nt
    s_mov_b32 exec_lo, 0x00ff00ff
    s_mov_b32 exec_hi, 0x00ff00ff
    buffer_load_dwordx4 v[140:143], v5, s[24:27], s68 offen offset:768 nt
    s_mov_b64 exec, -1
    s_add_u32 s68, s68, 896
    buffer_load_dwordx4 v[144:147], v5, s[24:27], s68 offen offset:0 nt
    buffer_load_dwordx4 v[148:151], v5, s[24:27], s68 offen offset:256 nt
    buffer_load_dwordx4 v[152:155], v5, s[24:27], s68 offen offset:512 nt
    s_mov_b32 exec_lo, 0x00ff00ff
    s_mov_b32 exec_hi, 0x00ff00ff
    buffer_load_dwordx4 v[156:159], v5, s[24:27], s68 offen offset:768 nt
    s_mov_b64 exec, -1
    s_add_u32 s68, s68, 896
    buffer_load_dwordx4 v[160:163], v5, s[24:27], s68 offen offset:0 nt
    buffer_load_dwordx4 v[164:167], v5, s[24:27], s68 offen offset:256 nt
    buffer_load_dwordx4 v[168:171], v5, s[24:27], s68 offen offset:512 nt
    s_mov_b32 exec_lo, 0x00ff00ff
    s_mov_b32 exec_hi, 0x00ff00ff
    buffer_load_dwordx4 v[172:175], v5, s[24:27], s68 offen offset:768 nt
    s_mov_b64 exec, -1
    s_add_u32 s68, s68, 896
    buffer_load_dwordx4 v[176:179], v5, s[24:27], s68 offen offset:0 nt
    buffer_load_dwordx4 v[180:183], v5, s[24:27], s68 offen offset:256 nt
    buffer_load_dwordx4 v[184:187], v5, s[24:27], s68 offen offset:512 nt
    s_mov_b32 exec_lo, 0x00ff00ff
    s_mov_b32 exec_hi, 0x00ff00ff
    buffer_load_dwordx4 v[188:191], v5, s[24:27], s68 offen offset:768 nt
    s_mov_b64 exec, -1
    s_add_u32 s68, s68, 896
    s_waitcnt vmcnt(28)
    v_perm_b32 v16, v40, v40, s82
    v_and_b32 v28, v16, v8
    v_and_b32 v29, v16, v9
    v_and_b32 v30, v16, v10
    v_and_b32 v31, v16, v11
    s_nop 1
    v_mfma_f32_16x16x32_bf16 v[48:51], v[28:31], v[64:67], v[48:51]
    v_mfma_f32_16x16x32_bf16 v[52:55], v[28:31], v[68:71], v[52:55]
    v_mfma_f32_16x16x32_bf16 v[56:59], v[28:31], v[72:75], v[56:59]
    v_mfma_f32_16x16x32_bf16 v[60:63], v[28:31], v[76:79], v[60:63]
    s_waitcnt vmcnt(24)
    v_perm_b32 v16, v40, v40, s83
    v_and_b32 v28, v16, v8
    v_and_b32 v29, v16, v9
    v_and_b32 v30, v16, v10
    v_and_b32 v31, v16, v11
    s_nop 1
    v_mfma_f32_16x16x32_bf16 v[48:51], v[28:31], v[80:83], v[48:51]
    v_mfma_f32_16x16x32_bf16 v[52:55], v[28:31], v[84:87], v[52:55]
    v_mfma_f32_16x16x32_bf16 v[56:59], v[28:31], v[88:91], v[56:59]
    v_mfma_f32_16x16x32_bf16 v[60:63], v[28:31], v[92:95], v[60:63]
    s_waitcnt vmcnt(20)
    v_perm_b32 v16, v41, v41, s82
    v_and_b32 v28, v16, v8
    v_and_b32 v29, v16, v9
    v_and_b32 v30, v16, v10
    v_and_b32 v31, v16, v11
    s_nop 1
    v_mfma_f32_16x16x32_bf16 v[48:51], v[28:31], v[96:99], v[48:51]
    v_mfma_f32_16x16x32_bf16 v[52:55], v[28:31], v[100:103], v[52:55]
    v_mfma_f32_16x16x32_bf16 v[56:59], v[28:31], v[104:107], v[56:59]
    v_mfma_f32_16x16x32_bf16 v[60:63], v[28:31], v[108:111], v[60:63]
    s_waitcnt vmcnt(16)
    v_perm_b32 v16, v41, v41, s83
    v_and_b32 v28, v16, v8
    v_and_b32 v29, v16, v9
    v_and_b32 v30, v16, v10
    v_and_b32 v31, v16, v11
    s_nop 1
    v_mfma_f32_16x16x32_bf16 v[48:51], v[28:31], v[112:115], v[48:51]
    v_mfma_f32_16x16x32_bf16 v[52:55], v[28:31], v[116:119], v[52:55]
    v_mfma_f32_16x16x32_bf16 v[56:59], v[28:31], v[120:123], v[56:59]
    v_mfma_f32_16x16x32_bf16 v[60:63], v[28:31], v[124:127], v[60:63]
    s_waitcnt vmcnt(12)
    v_perm_b32 v16, v42, v42, s82
    v_and_b32 v28, v16, v8
    v_and_b32 v29, v16, v9
    v_and_b32 v30, v16, v10
    v_and_b32 v31, v16, v11
    s_nop 1
    v_mfma_f32_16x16x32_bf16 v[48:51], v[28:31], v[128:131], v[48:51]
    v_mfma_f32_16x16x32_bf16 v[52:55], v[28:31], v[132:135], v[52:55]
    v_mfma_f32_16x16x32_bf16 v[56:59], v[28:31], v[136:139], v[56:59]
    v_mfma_f32_16x16x32_bf16 v[60:63], v[28:31], v[140:143], v[60:63]
    s_waitcnt vmcnt(8)
    v_perm_b32 v16, v42, v42, s83
    v_and_b32 v28, v16, v8
    v_and_b32 v29, v16, v9
    v_and_b32 v30, v16, v10
    v_and_b32 v31, v16, v11
    s_nop 1
    v_mfma_f32_16x16x32_bf16 v[48:51], v[28:31], v[144:147], v[48:51]
    v_mfma_f32_16x16x32_bf16 v[52:55], v[28:31], v[148:151], v[52:55]
    v_mfma_f32_16x16x32_bf16 v[56:59], v[28:31], v[152:155], v[56:59]
    v_mfma_f32_16x16x32_bf16 v[60:63], v[28:31], v[156:159], v[60:63]
    s_waitcnt vmcnt(4)
    v_perm_b32 v16, v43, v43, s82
    v_and_b32 v28, v16, v8
    v_and_b32 v29, v16, v9
    v_and_b32 v30, v16, v10
    v_and_b32 v31, v16, v11
    s_nop 1
    v_mfma_f32_16x16x32_bf16 v[48:51], v[28:31], v[160:163], v[48:51]
    v_mfma_f32_16x16x32_bf16 v[52:55], v[28:31], v[164:167], v[52:55]
    v_mfma_f32_16x16x32_bf16 v[56:59], v[28:31], v[168:171], v[56:59]
    v_mfma_f32_16x16x32_bf16 v[60:63], v[28:31], v[172:175], v[60:63]
    s_waitcnt vmcnt(0)
    v_perm_b32 v16, v43, v43, s83
    v_and_b32 v28, v16, v8
    v_and_b32 v29, v16, v9
    v_and_b32 v30, v16, v10
    v_and_b32 v31, v16, v11
    s_nop 1
    v_mfma_f32_16x16x32_bf16 v[48:51], v[28:31], v[176:179], v[48:51]
    v_mfma_f32_16x16x32_bf16 v[52:55], v[28:31], v[180:183], v[52:55]
    v_mfma_f32_16x16x32_bf16 v[56:59], v[28:31], v[184:187], v[56:59]
    v_mfma_f32_16x16x32_bf16 v[60:63], v[28:31], v[188:191], v[60:63]
    buffer_load_dwordx4 v[64:67], v5, s[24:27], s68 offen offset:0 nt
    buffer_load_dwordx4 v[68:71], v5, s[24:27], s68 offen offset:256 nt
    buffer_load_dwordx4 v[72:75], v5, s[24:27], s68 offen offset:512 nt
    s_mov_b32 exec_lo, 0x00ff00ff
    s_mov_b32 exec_hi, 0x00ff00ff
    buffer_load_dwordx4 v[76:79], v5, s[24:27], s68 offen offset:768 nt
    s_mov_b64 exec, -1
    s_add_u32 s68, s68, 896
    buffer_load_dwordx4 v[80:83], v5, s[24:27], s68 offen offset:0 nt
    buffer_load_dwordx4 v[84:87], v5, s[24:27], s68 offen offset:256 nt
    buffer_load_dwordx4 v[88:91], v5, s[24:27], s68 offen offset:512 nt
    s_mov_b32 exec_lo, 0x00ff00ff
    s_mov_b32 exec_hi, 0x00ff00ff
    buffer_load_dwordx4 v[92:95], v5, s[24:27], s68 offen offset:768 nt
    s_mov_b64 exec, -1
    s_add_u32 s68, s68, 896
    buffer_load_dwordx4 v[96:99], v5, s[24:27], s68 offen offset:0 nt
    buffer_load_dwordx4 v[100:103], v5, s[24:27], s68 offen offset:256 nt
    buffer_load_dwordx4 v[104:107], v5, s[24:27], s68 offen offset:512 nt
    s_mov_b32 exec_lo, 0x00ff00ff
    s_mov_b32 exec_hi, 0x00ff00ff
    buffer_load_dwordx4 v[108:111], v5, s[24:27], s68 offen offset:768 nt
    s_mov_b64 exec, -1
    s_add_u32 s68, s68, 896
    buffer_load_dwordx4 v[112:115], v5, s[24:27], s68 offen offset:0 nt
    buffer_load_dwordx4 v[116:119], v5, s[24:27], s68 offen offset:256 nt
    buffer_load_dwordx4 v[120:123], v5, s[24:27], s68 offen offset:512 nt
    s_mov_b32 exec_lo, 0x00ff00ff
    s_mov_b32 exec_hi, 0x00ff00ff
    buffer_load_dwordx4 v[124:127], v5, s[24:27], s68 offen offset:768 nt
    s_mov_b64 exec, -1
    s_add_u32 s68, s68, 896
    buffer_load_dwordx4 v[128:131], v5, s[24:27], s68 offen offset:0 nt
    buffer_load_dwordx4 v[132:135], v5, s[24:27], s68 offen offset:256 nt
    buffer_load_dwordx4 v[136:139], v5, s[24:27], s68 offen offset:512 nt
    s_mov_b32 exec_lo, 0x00ff00ff
    s_mov_b32 exec_hi, 0x00ff00ff
    buffer_load_dwordx4 v[140:143], v5, s[24:27], s68 offen offset:768 nt
    s_mov_b64 exec, -1
    s_add_u32 s68, s68, 896
    buffer_load_dwordx4 v[144:147], v5, s[24:27], s68 offen offset:0 nt
    buffer_load_dwordx4 v[148:151], v5, s[24:27], s68 offen offset:256 nt
    buffer_load_dwordx4 v[152:155], v5, s[24:27], s68 offen offset:512 nt
    s_mov_b32 exec_lo, 0x00ff00ff
    s_mov_b32 exec_hi, 0x00ff00ff
    buffer_load_dwordx4 v[156:159], v5, s[24:27], s68 offen offset:768 nt
    s_mov_b64 exec, -1
    s_add_u32 s68, s68, 896
    buffer_load_dwordx4 v[160:163], v5, s[24:27], s68 offen offset:0 nt
    buffer_load_dwordx4 v[164:167], v5, s[24:27], s68 offen offset:256 nt
    buffer_load_dwordx4 v[168:171], v5, s[24:27], s68 offen offset:512 nt
    s_mov_b32 exec_lo, 0x00ff00ff
    s_mov_b32 exec_hi, 0x00ff00ff
    buffer_load_dwordx4 v[172:175], v5, s[24:27], s68 offen offset:768 nt
    s_mov_b64 exec, -1
    s_add_u32 s68, s68, 896
    buffer_load_dwordx4 v[176:179], v5, s[24:27], s68 offen offset:0 nt
    buffer_load_dwordx4 v[180:183], v5, s[24:27], s68 offen offset:256 nt
    buffer_load_dwordx4 v[184:187], v5, s[24:27], s68 offen offset:512 nt
    s_mov_b32 exec_lo, 0x00ff00ff
    s_mov_b32 exec_hi, 0x00ff00ff
    buffer_load_dwordx4 v[188:191], v5, s[24:27], s68 offen offset:768 nt
    s_mov_b64 exec, -1
    s_add_u32 s68, s68, 896
    s_waitcnt vmcnt(28)
    v_perm_b32 v16, v44, v44, s82
    v_and_b32 v28, v16, v8
    v_and_b32 v29, v16, v9
    v_and_b32 v30, v16, v10
    v_and_b32 v31, v16, v11
    s_nop 1
    v_mfma_f32_16x16x32_bf16 v[48:51], v[28:31], v[64:67], v[48:51]
    v_mfma_f32_16x16x32_bf16 v[52:55], v[28:31], v[68:71], v[52:55]
    v_mfma_f32_16x16x32_bf16 v[56:59], v[28:31], v[72:75], v[56:59]
    v_mfma_f32_16x16x32_bf16 v[60:63], v[28:31], v[76:79], v[60:63]
    s_waitcnt vmcnt(24)
    v_perm_b32 v16, v44, v44, s83
    v_and_b32 v28, v16, v8
    v_and_b32 v29, v16, v9
    v_and_b32 v30, v16, v10
    v_and_b32 v31, v16, v11
    s_nop 1
    v_mfma_f32_16x16x32_bf16 v[48:51], v[28:31], v[80:83], v[48:51]
    v_mfma_f32_16x16x32_bf16 v[52:55], v[28:31], v[84:87], v[52:55]
    v_mfma_f32_16x16x32_bf16 v[56:59], v[28:31], v[88:91], v[56:59]
    v_mfma_f32_16x16x32_bf16 v[60:63], v[28:31], v[92:95], v[60:63]
    s_waitcnt vmcnt(20)
    v_perm_b32 v16, v45, v45, s82
    v_and_b32 v28, v16, v8
    v_and_b32 v29, v16, v9
    v_and_b32 v30, v16, v10
    v_and_b32 v31, v16, v11
    s_nop 1
    v_mfma_f32_16x16x32_bf16 v[48:51], v[28:31], v[96:99], v[48:51]
    v_mfma_f32_16x16x32_bf16 v[52:55], v[28:31], v[100:103], v[52:55]
    v_mfma_f32_16x16x32_bf16 v[56:59], v[28:31], v[104:107], v[56:59]
    v_mfma_f32_16x16x32_bf16 v[60:63], v[28:31], v[108:111], v[60:63]
    s_waitcnt vmcnt(16)
    v_perm_b32 v16, v45, v45, s83
    v_and_b32 v28, v16, v8
    v_and_b32 v29, v16, v9
    v_and_b32 v30, v16, v10
    v_and_b32 v31, v16, v11
    s_nop 1
    v_mfma_f32_16x16x32_bf16 v[48:51], v[28:31], v[112:115], v[48:51]
    v_mfma_f32_16x16x32_bf16 v[52:55], v[28:31], v[116:119], v[52:55]
    v_mfma_f32_16x16x32_bf16 v[56:59], v[28:31], v[120:123], v[56:59]
    v_mfma_f32_16x16x32_bf16 v[60:63], v[28:31], v[124:127], v[60:63]
    s_waitcnt vmcnt(12)
    v_perm_b32 v16, v46, v46, s82
    v_and_b32 v28, v16, v8
    v_and_b32 v29, v16, v9
    v_and_b32 v30, v16, v10
    v_and_b32 v31, v16, v11
    s_nop 1
    v_mfma_f32_16x16x32_bf16 v[48:51], v[28:31], v[128:131], v[48:51]
    v_mfma_f32_16x16x32_bf16 v[52:55], v[28:31], v[132:135], v[52:55]
    v_mfma_f32_16x16x32_bf16 v[56:59], v[28:31], v[136:139], v[56:59]
    v_mfma_f32_16x16x32_bf16 v[60:63], v[28:31], v[140:143], v[60:63]
    s_waitcnt vmcnt(8)
    v_perm_b32 v16, v46, v46, s83
    v_and_b32 v28, v16, v8
    v_and_b32 v29, v16, v9
    v_and_b32 v30, v16, v10
    v_and_b32 v31, v16, v11
    s_nop 1
    v_mfma_f32_16x16x32_bf16 v[48:51], v[28:31], v[144:147], v[48:51]
    v_mfma_f32_16x16x32_bf16 v[52:55], v[28:31], v[148:151], v[52:55]
    v_mfma_f32_16x16x32_bf16 v[56:59], v[28:31], v[152:155], v[56:59]
    v_mfma_f32_16x16x32_bf16 v[60:63], v[28:31], v[156:159], v[60:63]
    s_waitcnt vmcnt(4)
    v_perm_b32 v16, v47, v47, s82
    v_and_b32 v28, v16, v8
    v_and_b32 v29, v16, v9
    v_and_b32 v30, v16, v10
    v_and_b32 v31, v16, v11
    s_nop 1
    v_mfma_f32_16x16x32_bf16 v[48:51], v[28:31], v[160:163], v[48:51]
    v_mfma_f32_16x16x32_bf16 v[52:55], v[28:31], v[164:167], v[52:55]
    v_mfma_f32_16x16x32_bf16 v[56:59], v[28:31], v[168:171], v[56:59]
    v_mfma_f32_16x16x32_bf16 v[60:63], v[28:31], v[172:175], v[60:63]
    s_waitcnt vmcnt(0)
    v_perm_b32 v16, v47, v47, s83
    v_and_b32 v28, v16, v8
    v_and_b32 v29, v16, v9
    v_and_b32 v30, v16, v10
    v_and_b32 v31, v16, v11
    s_nop 1
    v_mfma_f32_16x16x32_bf16 v[48:51], v[28:31], v[176:179], v[48:51]
    v_mfma_f32_16x16x32_bf16 v[52:55], v[28:31], v[180:183], v[52:55]
    v_mfma_f32_16x16x32_bf16 v[56:59], v[28:31], v[184:187], v[56:59]
    v_mfma_f32_16x16x32_bf16 v[60:63], v[28:31], v[188:191], v[60:63]
    s_nop 7
    v_lshlrev_b32 v6, 1, v6
    s_lshl_b32 s66, s65, 11
    s_add_u32 s66, s66, 98304
    v_mov_b32 v49, v50
    v_mov_b32 v53, v54
    v_mov_b32 v57, v58
    v_mov_b32 v61, v62
    buffer_store_dwordx2 v[48:49], v6, s[12:15], s66 offen offset:0 sc1
    buffer_store_dwordx2 v[52:53], v6, s[12:15], s66 offen offset:512 sc1
    buffer_store_dwordx2 v[56:57], v6, s[12:15], s66 offen offset:1024 sc1
    buffer_store_dwordx2 v[60:61], v6, s[12:15], s66 offen offset:1536 sc1
    s_waitcnt vmcnt(0)
    v_mov_b32 v6, 1
    s_mov_b32 s73, 81920
    s_mov_b64 exec, 1
    buffer_atomic_add v6, v3, s[12:15], s73 offen offset:768 sc0
    s_waitcnt vmcnt(0)
    v_readfirstlane_b32 s72, v6
    s_cmp_lg_u32 s72, 13
    s_cbranch_scc1 L_sigb
    s_mov_b64 exec, 0xff
    v_lshlrev_b32 v7, 10, v1
    v_mov_b32 v6, 1
    buffer_store_dword v6, v7, s[12:15], s73 offen offset:420 sc1
L_sigb:
    s_mov_b64 exec, -1
    s_branch L_hfinal
L_h2:
    s_barrier
    s_barrier
    s_branch L_qpoll1
L_qpoll:
    s_sleep 16
L_qpoll1:
    buffer_load_dword v4, v3, s[16:19], s85 offen offset:64 sc1
    s_waitcnt vmcnt(0)
    v_readfirstlane_b32 s65, v4
    s_add_u32 s74, s74, 1
    s_cmp_gt_u32 s74, 1000000
    s_cbranch_scc1 L_qok
    s_cmp_eq_u32 s65, 0
    s_cbranch_scc1 L_qpoll
L_qok:
    v_lshlrev_b32 v4, 5, v1
    s_lshl_b32 s65, s61, 11
    buffer_load_dwordx4 v[32:35], v4, s[12:15], s65 offen offset:0 sc1
    buffer_load_dwordx4 v[36:39], v4, s[12:15], s65 offen offset:16 sc1
    s_add_u32 s65, s65, 16384
    buffer_load_dwordx4 v[40:43], v4, s[12:15], s65 offen offset:0 sc1
    buffer_load_dwordx4 v[44:47], v4, s[12:15], s65 offen offset:16 sc1
    s_add_u32 s65, s65, 16384
    buffer_load_dwordx4 v[48:51], v4, s[12:15], s65 offen offset:0 sc1
    buffer_load_dwordx4 v[52:55], v4, s[12:15], s65 offen offset:16 sc1
    s_add_u32 s65, s65, 16384
    buffer_load_dwordx4 v[56:59], v4, s[12:15], s65 offen offset:0 sc1
    buffer_load_dwordx4 v[60:63], v4, s[12:15], s65 offen offset:16 sc1
    s_add_u32 s65, s65, 16384
    s_waitcnt vmcnt(0)
    v_add_f32 v32, v32, v40
    v_add_f32 v48, v48, v56
    v_add_f32 v32, v32, v48
    v_add_f32 v33, v33, v41
    v_add_f32 v49, v49, v57
    v_add_f32 v33, v33, v49
    v_add_f32 v34, v34, v42
    v_add_f32 v50, v50, v58
    v_add_f32 v34, v34, v50
    v_add_f32 v35, v35, v43
    v_add_f32 v51, v51, v59
    v_add_f32 v35, v35, v51
    v_add_f32 v36, v36, v44
    v_add_f32 v52, v52, v60
    v_add_f32 v36, v36, v52
    v_add_f32 v37, v37, v45
    v_add_f32 v53, v53, v61
    v_add_f32 v37, v37, v53
    v_add_f32 v38, v38, v46
    v_add_f32 v54, v54, v62
    v_add_f32 v38, v38, v54
    v_add_f32 v39, v39, v47
    v_add_f32 v55, v55, v63
    v_add_f32 v39, v39, v55
    v_cvt_pk_bf16_f32 v20, v32, v33
    v_cvt_pk_bf16_f32 v21, v34, v35
    v_cvt_pk_bf16_f32 v22, v36, v37
    v_cvt_pk_bf16_f32 v23, v38, v39
    v_lshlrev_b32 v4, 4, v1
    ds_write_b128 v4, v[20:23] offset:0
    s_waitcnt lgkmcnt(0)
    s_barrier
L_hfinal:
    s_lshr_b32 s65, s2, 6
    s_cmp_lg_u32 s65, 3
    s_cbranch_scc1 L_hmref
    s_and_b32 s65, s2, 7
    s_cmp_eq_u32 s65, 7
    s_cbranch_scc1 L_hmref
    s_lshl_b32 s86, s65, 7
    s_lshl_b32 s65, s61, 4
    s_add_u32 s86, s86, s65
    s_mov_b32 s24, s40
    s_mov_b32 s25, s41
    s_mov_b32 s26, 3670016
    s_mov_b32 s27, 0x20000
    v_mul_u32_u24 v5, 896, v1
    s_sub_u32 s65, s60, 2
    s_mul_i32 s68, s65, 1835008
    s_add_u32 s68, s68, s86
    buffer_load_dwordx4 v[64:67], v5, s[24:27], s68 offen nt
    s_add_u32 s68, s68, 57344
    buffer_load_dwordx4 v[68:71], v5, s[24:27], s68 offen nt
    s_add_u32 s68, s68, 57344
    buffer_load_dwordx4 v[72:75], v5, s[24:27], s68 offen nt
    s_add_u32 s68, s68, 57344
    buffer_load_dwordx4 v[76:79], v5, s[24:27], s68 offen nt
    s_add_u32 s68, s68, 57344
    buffer_load_dwordx4 v[80:83], v5, s[24:27], s68 offen nt
    s_add_u32 s68, s68, 57344
    buffer_load_dwordx4 v[84:87], v5, s[24:27], s68 offen nt
    s_add_u32 s68, s68, 57344
    buffer_load_dwordx4 v[88:91], v5, s[24:27], s68 offen nt
    s_add_u32 s68, s68, 57344
    buffer_load_dwordx4 v[92:95], v5, s[24:27], s68 offen nt
    s_add_u32 s68, s68, 57344
    s_waitcnt vmcnt(0)
    buffer_load_dwordx4 v[96:99], v5, s[24:27], s68 offen nt
    s_add_u32 s68, s68, 57344
    buffer_load_dwordx4 v[100:103], v5, s[24:27], s68 offen nt
    s_add_u32 s68, s68, 57344
    buffer_load_dwordx4 v[104:107], v5, s[24:27], s68 offen nt
    s_add_u32 s68, s68, 57344
    buffer_load_dwordx4 v[108:111], v5, s[24:27], s68 offen nt
    s_add_u32 s68, s68, 57344
    buffer_load_dwordx4 v[112:115], v5, s[24:27], s68 offen nt
    s_add_u32 s68, s68, 57344
    buffer_load_dwordx4 v[116:119], v5, s[24:27], s68 offen nt
    s_add_u32 s68, s68, 57344
    buffer_load_dwordx4 v[120:123], v5, s[24:27], s68 offen nt
    s_add_u32 s68, s68, 57344
    buffer_load_dwordx4 v[124:127], v5, s[24:27], s68 offen nt
    s_add_u32 s68, s68, 57344
    s_waitcnt vmcnt(0)
    buffer_load_dwordx4 v[128:131], v5, s[24:27], s68 offen nt
    s_add_u32 s68, s68, 57344
    buffer_load_dwordx4 v[132:135], v5, s[24:27], s68 offen nt
    s_add_u32 s68, s68, 57344
    buffer_load_dwordx4 v[136:139], v5, s[24:27], s68 offen nt
    s_add_u32 s68, s68, 57344
    buffer_load_dwordx4 v[140:143], v5, s[24:27], s68 offen nt
    s_add_u32 s68, s68, 57344
    buffer_load_dwordx4 v[144:147], v5, s[24:27], s68 offen nt
    s_add_u32 s68, s68, 57344
    buffer_load_dwordx4 v[148:151], v5, s[24:27], s68 offen nt
    s_add_u32 s68, s68, 57344
    buffer_load_dwordx4 v[152:155], v5, s[24:27], s68 offen nt
    s_add_u32 s68, s68, 57344
    buffer_load_dwordx4 v[156:159], v5, s[24:27], s68 offen nt
    s_add_u32 s68, s68, 57344
    s_waitcnt vmcnt(0)
    buffer_load_dwordx4 v[160:163], v5, s[24:27], s68 offen nt
    s_add_u32 s68, s68, 57344
    buffer_load_dwordx4 v[164:167], v5, s[24:27], s68 offen nt
    s_add_u32 s68, s68, 57344
    buffer_load_dwordx4 v[168:171], v5, s[24:27], s68 offen nt
    s_add_u32 s68, s68, 57344
    buffer_load_dwordx4 v[172:175], v5, s[24:27], s68 offen nt
    s_add_u32 s68, s68, 57344
    buffer_load_dwordx4 v[176:179], v5, s[24:27], s68 offen nt
    s_add_u32 s68, s68, 57344
    buffer_load_dwordx4 v[180:183], v5, s[24:27], s68 offen nt
    s_add_u32 s68, s68, 57344
    buffer_load_dwordx4 v[184:187], v5, s[24:27], s68 offen nt
    s_add_u32 s68, s68, 57344
    buffer_load_dwordx4 v[188:191], v5, s[24:27], s68 offen nt
    s_add_u32 s68, s68, 57344
    s_waitcnt vmcnt(0)
    s_mov_b32 s69, 0x05040100
    s_mov_b32 s70, 0x07060302
    s_waitcnt vmcnt(0)
    v_perm_b32 v4, v68, v64, s69
    v_perm_b32 v68, v68, v64, s70
    v_mov_b32 v64, v4
    v_perm_b32 v4, v69, v65, s69
    v_perm_b32 v69, v69, v65, s70
    v_mov_b32 v65, v4
    v_perm_b32 v4, v70, v66, s69
    v_perm_b32 v70, v70, v66, s70
    v_mov_b32 v66, v4
    v_perm_b32 v4, v71, v67, s69
    v_perm_b32 v71, v71, v67, s70
    v_mov_b32 v67, v4
    v_perm_b32 v4, v76, v72, s69
    v_perm_b32 v76, v76, v72, s70
    v_mov_b32 v72, v4
    v_perm_b32 v4, v77, v73, s69
    v_perm_b32 v77, v77, v73, s70
    v_mov_b32 v73, v4
    v_perm_b32 v4, v78, v74, s69
    v_perm_b32 v78, v78, v74, s70
    v_mov_b32 v74, v4
    v_perm_b32 v4, v79, v75, s69
    v_perm_b32 v79, v79, v75, s70
    v_mov_b32 v75, v4
    v_perm_b32 v4, v84, v80, s69
    v_perm_b32 v84, v84, v80, s70
    v_mov_b32 v80, v4
    v_perm_b32 v4, v85, v81, s69
    v_perm_b32 v85, v85, v81, s70
    v_mov_b32 v81, v4
    v_perm_b32 v4, v86, v82, s69
    v_perm_b32 v86, v86, v82, s70
    v_mov_b32 v82, v4
    v_perm_b32 v4, v87, v83, s69
    v_perm_b32 v87, v87, v83, s70
    v_mov_b32 v83, v4
    v_perm_b32 v4, v92, v88, s69
    v_perm_b32 v92, v92, v88, s70
    v_mov_b32 v88, v4
    v_perm_b32 v4, v93, v89, s69
    v_perm_b32 v93, v93, v89, s70
    v_mov_b32 v89, v4
    v_perm_b32 v4, v94, v90, s69
    v_perm_b32 v94, v94, v90, s70
    v_mov_b32 v90, v4
    v_perm_b32 v4, v95, v91, s69
    v_perm_b32 v95, v95, v91, s70
    v_mov_b32 v91, v4
    v_perm_b32 v4, v100, v96, s69
    v_perm_b32 v100, v100, v96, s70
    v_mov_b32 v96, v4
    v_perm_b32 v4, v101, v97, s69
    v_perm_b32 v101, v101, v97, s70
    v_mov_b32 v97, v4
    v_perm_b32 v4, v102, v98, s69
    v_perm_b32 v102, v102, v98, s70
    v_mov_b32 v98, v4
    v_perm_b32 v4, v103, v99, s69
    v_perm_b32 v103, v103, v99, s70
    v_mov_b32 v99, v4
    v_perm_b32 v4, v108, v104, s69
    v_perm_b32 v108, v108, v104, s70
    v_mov_b32 v104, v4
    v_perm_b32 v4, v109, v105, s69
    v_perm_b32 v109, v109, v105, s70
    v_mov_b32 v105, v4
    v_perm_b32 v4, v110, v106, s69
    v_perm_b32 v110, v110, v106, s70
    v_mov_b32 v106, v4
    v_perm_b32 v4, v111, v107, s69
    v_perm_b32 v111, v111, v107, s70
    v_mov_b32 v107, v4
    v_perm_b32 v4, v116, v112, s69
    v_perm_b32 v116, v116, v112, s70
    v_mov_b32 v112, v4
    v_perm_b32 v4, v117, v113, s69
    v_perm_b32 v117, v117, v113, s70
    v_mov_b32 v113, v4
    v_perm_b32 v4, v118, v114, s69
    v_perm_b32 v118, v118, v114, s70
    v_mov_b32 v114, v4
    v_perm_b32 v4, v119, v115, s69
    v_perm_b32 v119, v119, v115, s70
    v_mov_b32 v115, v4
    v_perm_b32 v4, v124, v120, s69
    v_perm_b32 v124, v124, v120, s70
    v_mov_b32 v120, v4
    v_perm_b32 v4, v125, v121, s69
    v_perm_b32 v125, v125, v121, s70
    v_mov_b32 v121, v4
    v_perm_b32 v4, v126, v122, s69
    v_perm_b32 v126, v126, v122, s70
    v_mov_b32 v122, v4
    v_perm_b32 v4, v127, v123, s69
    v_perm_b32 v127, v127, v123, s70
    v_mov_b32 v123, v4
    v_perm_b32 v4, v132, v128, s69
    v_perm_b32 v132, v132, v128, s70
    v_mov_b32 v128, v4
    v_perm_b32 v4, v133, v129, s69
    v_perm_b32 v133, v133, v129, s70
    v_mov_b32 v129, v4
    v_perm_b32 v4, v134, v130, s69
    v_perm_b32 v134, v134, v130, s70
    v_mov_b32 v130, v4
    v_perm_b32 v4, v135, v131, s69
    v_perm_b32 v135, v135, v131, s70
    v_mov_b32 v131, v4
    v_perm_b32 v4, v140, v136, s69
    v_perm_b32 v140, v140, v136, s70
    v_mov_b32 v136, v4
    v_perm_b32 v4, v141, v137, s69
    v_perm_b32 v141, v141, v137, s70
    v_mov_b32 v137, v4
    v_perm_b32 v4, v142, v138, s69
    v_perm_b32 v142, v142, v138, s70
    v_mov_b32 v138, v4
    v_perm_b32 v4, v143, v139, s69
    v_perm_b32 v143, v143, v139, s70
    v_mov_b32 v139, v4
    v_perm_b32 v4, v148, v144, s69
    v_perm_b32 v148, v148, v144, s70
    v_mov_b32 v144, v4
    v_perm_b32 v4, v149, v145, s69
    v_perm_b32 v149, v149, v145, s70
    v_mov_b32 v145, v4
    v_perm_b32 v4, v150, v146, s69
    v_perm_b32 v150, v150, v146, s70
    v_mov_b32 v146, v4
    v_perm_b32 v4, v151, v147, s69
    v_perm_b32 v151, v151, v147, s70
    v_mov_b32 v147, v4
    v_perm_b32 v4, v156, v152, s69
    v_perm_b32 v156, v156, v152, s70
    v_mov_b32 v152, v4
    v_perm_b32 v4, v157, v153, s69
    v_perm_b32 v157, v157, v153, s70
    v_mov_b32 v153, v4
    v_perm_b32 v4, v158, v154, s69
    v_perm_b32 v158, v158, v154, s70
    v_mov_b32 v154, v4
    v_perm_b32 v4, v159, v155, s69
    v_perm_b32 v159, v159, v155, s70
    v_mov_b32 v155, v4
    v_perm_b32 v4, v164, v160, s69
    v_perm_b32 v164, v164, v160, s70
    v_mov_b32 v160, v4
    v_perm_b32 v4, v165, v161, s69
    v_perm_b32 v165, v165, v161, s70
    v_mov_b32 v161, v4
    v_perm_b32 v4, v166, v162, s69
    v_perm_b32 v166, v166, v162, s70
    v_mov_b32 v162, v4
    v_perm_b32 v4, v167, v163, s69
    v_perm_b32 v167, v167, v163, s70
    v_mov_b32 v163, v4
    v_perm_b32 v4, v172, v168, s69
    v_perm_b32 v172, v172, v168, s70
    v_mov_b32 v168, v4
    v_perm_b32 v4, v173, v169, s69
    v_perm_b32 v173, v173, v169, s70
    v_mov_b32 v169, v4
    v_perm_b32 v4, v174, v170, s69
    v_perm_b32 v174, v174, v170, s70
    v_mov_b32 v170, v4
    v_perm_b32 v4, v175, v171, s69
    v_perm_b32 v175, v175, v171, s70
    v_mov_b32 v171, v4
    v_perm_b32 v4, v180, v176, s69
    v_perm_b32 v180, v180, v176, s70
    v_mov_b32 v176, v4
    v_perm_b32 v4, v181, v177, s69
    v_perm_b32 v181, v181, v177, s70
    v_mov_b32 v177, v4
    v_perm_b32 v4, v182, v178, s69
    v_perm_b32 v182, v182, v178, s70
    v_mov_b32 v178, v4
    v_perm_b32 v4, v183, v179, s69
    v_perm_b32 v183, v183, v179, s70
    v_mov_b32 v179, v4
    v_perm_b32 v4, v188, v184, s69
    v_perm_b32 v188, v188, v184, s70
    v_mov_b32 v184, v4
    v_perm_b32 v4, v189, v185, s69
    v_perm_b32 v189, v189, v185, s70
    v_mov_b32 v185, v4
    v_perm_b32 v4, v190, v186, s69
    v_perm_b32 v190, v190, v186, s70
    v_mov_b32 v186, v4
    v_perm_b32 v4, v191, v187, s69
    v_perm_b32 v191, v191, v187, s70
    v_mov_b32 v187, v4
L_skipwot:
    s_cmp_lg_u32 s60, 2
    s_cbranch_scc1 L_hmref
L_bpoll:
    buffer_load_dword v4, v3, s[12:15], s84 offen offset:420 sc1
    s_waitcnt vmcnt(0)
    v_readfirstlane_b32 s65, v4
    s_add_u32 s74, s74, 1
    s_cmp_gt_u32 s74, 1000000
    s_cbranch_scc1 L_bpoll_ok
    s_cmp_lg_u32 s65, 0
    s_cbranch_scc1 L_bpoll_ok
    s_sleep 127
    s_branch L_bpoll
L_bpoll_ok:
    v_lshrrev_b32 v4, 2, v1
    v_lshlrev_b32 v4, 11, v4
    v_and_b32 v5, 3, v1
    v_lshl_add_u32 v4, v5, 3, v4
    s_lshl_b32 s65, s86, 1
    s_add_u32 s65, s65, 98304
    v_mov_b32 v250, 0
    v_mov_b32 v251, 0
    s_mov_b32 exec_hi, 0x00ffffff
    buffer_load_dwordx2 v[250:251], v4, s[12:15], s65 offen sc1
    s_mov_b64 exec, -1
    s_mov_b32 s24, s52
    s_mov_b32 s25, s53
    s_mov_b32 s26, 896
    s_mov_b32 s27, 0x20000
    s_mov_b32 s28, s50
    s_mov_b32 s29, s51
    s_mov_b32 s30, 896
    s_mov_b32 s31, 0x20000
    v_lshlrev_b32 v4, 4, v1
    buffer_load_dwordx4 v[32:35], v4, s[20:23], 0 offen
    buffer_load_dwordx4 v[36:39], v4, s[24:27], 0 offen
    v_lshlrev_b32 v5, 2, v1
    buffer_load_dword v252, v5, s[28:31], s86 offen
    s_waitcnt vmcnt(0)
    s_nop 1
    v_add_f32_dpp v250, v250, v250 row_ror:4 row_mask:0xf bank_mask:0xf
    s_nop 1
    v_add_f32_dpp v250, v250, v250 row_ror:8 row_mask:0xf bank_mask:0xf
    v_mov_b32 v4, v250
    s_nop 1
    v_permlane16_swap_b32 v250, v4
    v_add_f32 v250, v250, v4
    v_mov_b32 v4, v250
    s_nop 1
    v_permlane32_swap_b32 v250, v4
    v_add_f32 v250, v250, v4
    s_nop 1
    v_add_f32_dpp v251, v251, v251 row_ror:4 row_mask:0xf bank_mask:0xf
    s_nop 1
    v_add_f32_dpp v251, v251, v251 row_ror:8 row_mask:0xf bank_mask:0xf
    v_mov_b32 v4, v251
    s_nop 1
    v_permlane16_swap_b32 v251, v4
    v_add_f32 v251, v251, v4
    v_mov_b32 v4, v251
    s_nop 1
    v_permlane32_swap_b32 v251, v4
    v_add_f32 v251, v251, v4
    v_mov_b32 v40, 0
    v_lshlrev_b32 v4, 16, v32
    v_lshlrev_b32 v5, 16, v36
    v_mul_f32 v4, v4, v5
    v_and_b32 v6, 0xffff0000, v32
    v_and_b32 v7, 0xffff0000, v36
    v_mul_f32 v6, v6, v7
    v_cvt_pk_bf16_f32 v4, v4, v6
    v_lshlrev_b32 v5, 16, v4
    v_and_b32 v4, 0xffff0000, v4
    v_add_f32 v40, v40, v5
    v_add_f32 v40, v40, v4
    v_lshlrev_b32 v4, 16, v33
    v_lshlrev_b32 v5, 16, v37
    v_mul_f32 v4, v4, v5
    v_and_b32 v6, 0xffff0000, v33
    v_and_b32 v7, 0xffff0000, v37
    v_mul_f32 v6, v6, v7
    v_cvt_pk_bf16_f32 v4, v4, v6
    v_lshlrev_b32 v5, 16, v4
    v_and_b32 v4, 0xffff0000, v4
    v_add_f32 v40, v40, v5
    v_add_f32 v40, v40, v4
    v_lshlrev_b32 v4, 16, v34
    v_lshlrev_b32 v5, 16, v38
    v_mul_f32 v4, v4, v5
    v_and_b32 v6, 0xffff0000, v34
    v_and_b32 v7, 0xffff0000, v38
    v_mul_f32 v6, v6, v7
    v_cvt_pk_bf16_f32 v4, v4, v6
    v_lshlrev_b32 v5, 16, v4
    v_and_b32 v4, 0xffff0000, v4
    v_add_f32 v40, v40, v5
    v_add_f32 v40, v40, v4
    v_lshlrev_b32 v4, 16, v35
    v_lshlrev_b32 v5, 16, v39
    v_mul_f32 v4, v4, v5
    v_and_b32 v6, 0xffff0000, v35
    v_and_b32 v7, 0xffff0000, v39
    v_mul_f32 v6, v6, v7
    v_cvt_pk_bf16_f32 v4, v4, v6
    v_lshlrev_b32 v5, 16, v4
    v_and_b32 v4, 0xffff0000, v4
    v_add_f32 v40, v40, v5
    v_add_f32 v40, v40, v4
    s_nop 1
    v_add_f32_dpp v40, v40, v40 quad_perm:[1,0,3,2] row_mask:0xf bank_mask:0xf
    s_nop 1
    v_add_f32_dpp v40, v40, v40 quad_perm:[2,3,0,1] row_mask:0xf bank_mask:0xf
    s_nop 1
    v_add_f32_dpp v40, v40, v40 row_half_mirror row_mask:0xf bank_mask:0xf
    s_nop 1
    v_add_f32_dpp v40, v40, v40 row_mirror row_mask:0xf bank_mask:0xf
    v_mov_b32 v4, v40
    s_nop 1
    v_permlane16_swap_b32 v40, v4
    v_add_f32 v40, v40, v4
    v_mov_b32 v4, v40
    s_nop 1
    v_permlane32_swap_b32 v40, v4
    v_add_f32 v40, v40, v4
    v_cvt_pk_bf16_f32 v40, v40, v40
    v_and_b32 v40, 0xffff0000, v40
    v_mul_f32 v40, 0xbfb8aa3b, v40
    v_exp_f32 v40, v40
    s_nop 0
    v_add_f32 v40, 1.0, v40
    v_rcp_f32 v40, v40
    s_nop 0
    v_cvt_pk_bf16_f32 v40, v40, v40
    v_and_b32 v40, 0xffff0000, v40
    v_mov_b32 v253, v40
    v_sub_f32 v24, 1.0, v253
    v_cvt_pk_bf16_f32 v24, v24, v24
    v_and_b32 v24, 0xffff0000, v24
    v_lshlrev_b32 v26, 16, v252
    v_and_b32 v27, 0xffff0000, v252
    v_cvt_pk_bf16_f32 v250, v250, v250
    v_and_b32 v250, 0xffff0000, v250
    v_add_f32 v250, v250, v26
    v_cvt_pk_bf16_f32 v250, v250, v250
    v_and_b32 v250, 0xffff0000, v250
    v_mul_f32 v250, v24, v250
    v_cvt_pk_bf16_f32 v250, v250, v250
    v_and_b32 v250, 0xffff0000, v250
    v_cvt_pk_bf16_f32 v251, v251, v251
    v_and_b32 v251, 0xffff0000, v251
    v_add_f32 v251, v251, v27
    v_cvt_pk_bf16_f32 v251, v251, v251
    v_and_b32 v251, 0xffff0000, v251
    v_mul_f32 v251, v24, v251
    v_cvt_pk_bf16_f32 v251, v251, v251
    v_and_b32 v251, 0xffff0000, v251
L_hmref:
    s_cmp_lg_u32 s60, 2
    s_cbranch_scc1 L_hb2
L_mpoll:
    s_sleep 127
    s_sleep 127
    s_sleep 127
    s_sleep 127
    buffer_load_dwordx3 v[4:6], v3, s[12:15], s84 offen offset:512 sc1
    s_waitcnt vmcnt(0)
    v_readfirstlane_b32 s65, v6
    s_add_u32 s74, s74, 1
    s_cmp_gt_u32 s74, 1000000
    s_cbranch_scc1 L_mok
    s_cmp_eq_u32 s65, 0
    s_cbranch_scc1 L_mpoll
L_mok:
    s_mov_b64 exec, 1
    ds_write_b64 v3, v[4:5] offset:5152
    s_mov_b64 exec, -1
L_hb2:
    s_waitcnt lgkmcnt(0)
    s_barrier
    s_sub_u32 s65, s60, 2
    s_lshl_b32 s65, s65, 2
    v_mov_b32 v4, s65
    ds_read_b32 v16, v4 offset:5120
    ds_read_b32 v17, v4 offset:5128
    ds_read_b32 v18, v4 offset:5136
    ds_read_b32 v19, v4 offset:5144
    ds_read_b32 v25, v4 offset:5152
    s_lshl_b32 s65, s65, 8
    v_lshlrev_b32 v5, 4, v1
    v_add_u32 v6, s65, v5
    ds_read_b128 v[32:35], v6 offset:1024
    ds_read_b128 v[36:39], v6 offset:3072
    s_waitcnt lgkmcnt(2)
    v_max_f32 v22, v16, v18
    v_sub_f32 v20, v16, v22
    v_sub_f32 v21, v18, v22
    v_sub_f32 v24, v22, v25
    v_exp_f32 v20, v20
    v_exp_f32 v21, v21
    v_exp_f32 v26, v24
    s_nop 0
    v_mul_f32 v23, v20, v17
    v_fma_f32 v23, v21, v19, v23
    s_waitcnt lgkmcnt(0)
    v_mul_f32 v32, v20, v32
    v_fma_f32 v32, v21, v36, v32
    v_mul_f32 v33, v20, v33
    v_fma_f32 v33, v21, v37, v33
    v_mul_f32 v34, v20, v34
    v_fma_f32 v34, v21, v38, v34
    v_mul_f32 v35, v20, v35
    v_fma_f32 v35, v21, v39, v35
    s_lshl_b32 s66, s2, 12
    s_add_u32 s66, s66, 131072
    buffer_store_dwordx4 v[32:35], v6, s[12:15], s66 offen sc1
    s_lshr_b32 s65, s65, 7
    s_add_u32 s66, s66, s65
    s_mov_b64 exec, 1
    buffer_store_dwordx2 v[22:23], v3, s[12:15], s66 offen offset:2048 sc1
    s_mov_b64 exec, -1
    s_waitcnt vmcnt(0)
    s_barrier
    s_lshr_b32 s65, s2, 6
    s_cmp_lg_u32 s65, 3
    s_cbranch_scc1 L_done
    s_and_b32 s65, s2, 7
    s_cmp_eq_u32 s65, 7
    s_cbranch_scc1 L_done
    v_and_b32 v4, 7, v1
    v_lshlrev_b32 v4, 2, v4
    s_mov_b32 s74, 0
    v_lshlrev_b32 v14, 2, v1
    s_sub_u32 s71, s60, 2
    s_lshl_b32 s67, s71, 13
    s_add_u32 s67, s67, 65536
    s_add_u32 s68, s67, 4096
    s_lshl_b32 s69, s71, 12
    s_add_u32 s69, s69, 81920
    v_mov_b32 v48, 0
    v_mov_b32 v49, 0
    v_mov_b32 v50, 0
    v_mov_b32 v51, 0
    v_mov_b32 v52, 0
    v_mov_b32 v53, 0
    v_mov_b32 v54, 0
    v_mov_b32 v55, 0
    s_cmp_lg_u32 s60, 2
    s_cbranch_scc1 L_aok
L_apoll:
    buffer_load_dword v5, v4, s[12:15], s84 offen offset:384 sc1
    s_waitcnt vmcnt(0)
    v_cmp_eq_u32 vcc, 0, v5
    s_add_u32 s74, s74, 1
    s_cmp_gt_u32 s74, 1000000
    s_cbranch_scc1 L_aok
    s_cbranch_vccz L_aok
    s_sleep 1
    s_branch L_apoll
L_aok:
    s_barrier
    buffer_load_dword v6, v3, s[16:19], 0 offen offset:32 sc1
    buffer_load_dwordx2 v[56:57], v3, s[12:15], s69 offen offset:256 sc1
    buffer_load_dwordx2 v[58:59], v3, s[12:15], s69 offen offset:1280 sc1
    buffer_load_dwordx2 v[60:61], v3, s[12:15], s69 offen offset:2304 sc1
    buffer_load_dwordx2 v[62:63], v3, s[12:15], s69 offen offset:3328 sc1
    buffer_load_dword v16, v14, s[12:15], s67 offen offset:0 sc1
    buffer_load_dword v17, v14, s[12:15], s67 offen offset:256 sc1
    buffer_load_dword v18, v14, s[12:15], s67 offen offset:512 sc1
    buffer_load_dword v19, v14, s[12:15], s67 offen offset:768 sc1
    buffer_load_dword v20, v14, s[12:15], s67 offen offset:1024 sc1
    buffer_load_dword v21, v14, s[12:15], s67 offen offset:1280 sc1
    buffer_load_dword v22, v14, s[12:15], s67 offen offset:1536 sc1
    buffer_load_dword v23, v14, s[12:15], s67 offen offset:1792 sc1
    buffer_load_dword v24, v14, s[12:15], s67 offen offset:2048 sc1
    buffer_load_dword v25, v14, s[12:15], s67 offen offset:2304 sc1
    buffer_load_dword v26, v14, s[12:15], s67 offen offset:2560 sc1
    buffer_load_dword v27, v14, s[12:15], s67 offen offset:2816 sc1
    buffer_load_dword v28, v14, s[12:15], s67 offen offset:3072 sc1
    buffer_load_dword v29, v14, s[12:15], s67 offen offset:3328 sc1
    buffer_load_dword v30, v14, s[12:15], s67 offen offset:3584 sc1
    buffer_load_dword v31, v14, s[12:15], s67 offen offset:3840 sc1
    buffer_load_dword v32, v14, s[12:15], s68 offen offset:0 sc1
    buffer_load_dword v33, v14, s[12:15], s68 offen offset:256 sc1
    buffer_load_dword v34, v14, s[12:15], s68 offen offset:512 sc1
    buffer_load_dword v35, v14, s[12:15], s68 offen offset:768 sc1
    buffer_load_dword v36, v14, s[12:15], s68 offen offset:1024 sc1
    buffer_load_dword v37, v14, s[12:15], s68 offen offset:1280 sc1
    buffer_load_dword v38, v14, s[12:15], s68 offen offset:1536 sc1
    buffer_load_dword v39, v14, s[12:15], s68 offen offset:1792 sc1
    buffer_load_dword v40, v14, s[12:15], s68 offen offset:2048 sc1
    buffer_load_dword v41, v14, s[12:15], s68 offen offset:2304 sc1
    buffer_load_dword v42, v14, s[12:15], s68 offen offset:2560 sc1
    buffer_load_dword v43, v14, s[12:15], s68 offen offset:2816 sc1
    buffer_load_dword v44, v14, s[12:15], s68 offen offset:3072 sc1
    buffer_load_dword v45, v14, s[12:15], s68 offen offset:3328 sc1
    buffer_load_dword v46, v14, s[12:15], s68 offen offset:3584 sc1
    buffer_load_dword v47, v14, s[12:15], s68 offen offset:3840 sc1
    s_waitcnt vmcnt(32)
    v_readfirstlane_b32 s65, v6
    s_cmp_lg_u32 s65, 0
    s_cbranch_scc1 L_fallback
L_fast:
    v_rcp_f32 v56, v56
    v_rcp_f32 v57, v57
    v_rcp_f32 v58, v58
    v_rcp_f32 v59, v59
    v_rcp_f32 v60, v60
    v_rcp_f32 v61, v61
    v_rcp_f32 v62, v62
    v_rcp_f32 v63, v63
    s_waitcnt vmcnt(0)
    v_mul_f32 v16, v56, v16
    v_mul_f32 v17, v56, v17
    v_cvt_pk_bf16_f32 v16, v16, v17
    v_mul_f32 v18, v56, v18
    v_mul_f32 v19, v56, v19
    v_cvt_pk_bf16_f32 v17, v18, v19
    v_mul_f32 v20, v57, v20
    v_mul_f32 v21, v57, v21
    v_cvt_pk_bf16_f32 v18, v20, v21
    v_mul_f32 v22, v57, v22
    v_mul_f32 v23, v57, v23
    v_cvt_pk_bf16_f32 v19, v22, v23
    v_mul_f32 v24, v58, v24
    v_mul_f32 v25, v58, v25
    v_cvt_pk_bf16_f32 v20, v24, v25
    v_mul_f32 v26, v58, v26
    v_mul_f32 v27, v58, v27
    v_cvt_pk_bf16_f32 v21, v26, v27
    v_mul_f32 v28, v59, v28
    v_mul_f32 v29, v59, v29
    v_cvt_pk_bf16_f32 v22, v28, v29
    v_mul_f32 v30, v59, v30
    v_mul_f32 v31, v59, v31
    v_cvt_pk_bf16_f32 v23, v30, v31
    v_mul_f32 v32, v60, v32
    v_mul_f32 v33, v60, v33
    v_cvt_pk_bf16_f32 v24, v32, v33
    v_mul_f32 v34, v60, v34
    v_mul_f32 v35, v60, v35
    v_cvt_pk_bf16_f32 v25, v34, v35
    v_mul_f32 v36, v61, v36
    v_mul_f32 v37, v61, v37
    v_cvt_pk_bf16_f32 v26, v36, v37
    v_mul_f32 v38, v61, v38
    v_mul_f32 v39, v61, v39
    v_cvt_pk_bf16_f32 v27, v38, v39
    v_mul_f32 v40, v62, v40
    v_mul_f32 v41, v62, v41
    v_cvt_pk_bf16_f32 v28, v40, v41
    v_mul_f32 v42, v62, v42
    v_mul_f32 v43, v62, v43
    v_cvt_pk_bf16_f32 v29, v42, v43
    v_mul_f32 v44, v63, v44
    v_mul_f32 v45, v63, v45
    v_cvt_pk_bf16_f32 v30, v44, v45
    v_mul_f32 v46, v63, v46
    v_mul_f32 v47, v63, v47
    v_cvt_pk_bf16_f32 v31, v46, v47
    v_dot2_f32_bf16 v48, v64, v16, v48
    v_dot2_f32_bf16 v49, v68, v16, v49
    v_dot2_f32_bf16 v50, v65, v16, v50
    v_dot2_f32_bf16 v51, v69, v16, v51
    v_dot2_f32_bf16 v52, v66, v16, v52
    v_dot2_f32_bf16 v53, v70, v16, v53
    v_dot2_f32_bf16 v54, v67, v16, v54
    v_dot2_f32_bf16 v55, v71, v16, v55
    v_dot2_f32_bf16 v48, v72, v17, v48
    v_dot2_f32_bf16 v49, v76, v17, v49
    v_dot2_f32_bf16 v50, v73, v17, v50
    v_dot2_f32_bf16 v51, v77, v17, v51
    v_dot2_f32_bf16 v52, v74, v17, v52
    v_dot2_f32_bf16 v53, v78, v17, v53
    v_dot2_f32_bf16 v54, v75, v17, v54
    v_dot2_f32_bf16 v55, v79, v17, v55
    v_dot2_f32_bf16 v48, v80, v18, v48
    v_dot2_f32_bf16 v49, v84, v18, v49
    v_dot2_f32_bf16 v50, v81, v18, v50
    v_dot2_f32_bf16 v51, v85, v18, v51
    v_dot2_f32_bf16 v52, v82, v18, v52
    v_dot2_f32_bf16 v53, v86, v18, v53
    v_dot2_f32_bf16 v54, v83, v18, v54
    v_dot2_f32_bf16 v55, v87, v18, v55
    v_dot2_f32_bf16 v48, v88, v19, v48
    v_dot2_f32_bf16 v49, v92, v19, v49
    v_dot2_f32_bf16 v50, v89, v19, v50
    v_dot2_f32_bf16 v51, v93, v19, v51
    v_dot2_f32_bf16 v52, v90, v19, v52
    v_dot2_f32_bf16 v53, v94, v19, v53
    v_dot2_f32_bf16 v54, v91, v19, v54
    v_dot2_f32_bf16 v55, v95, v19, v55
    v_dot2_f32_bf16 v48, v96, v20, v48
    v_dot2_f32_bf16 v49, v100, v20, v49
    v_dot2_f32_bf16 v50, v97, v20, v50
    v_dot2_f32_bf16 v51, v101, v20, v51
    v_dot2_f32_bf16 v52, v98, v20, v52
    v_dot2_f32_bf16 v53, v102, v20, v53
    v_dot2_f32_bf16 v54, v99, v20, v54
    v_dot2_f32_bf16 v55, v103, v20, v55
    v_dot2_f32_bf16 v48, v104, v21, v48
    v_dot2_f32_bf16 v49, v108, v21, v49
    v_dot2_f32_bf16 v50, v105, v21, v50
    v_dot2_f32_bf16 v51, v109, v21, v51
    v_dot2_f32_bf16 v52, v106, v21, v52
    v_dot2_f32_bf16 v53, v110, v21, v53
    v_dot2_f32_bf16 v54, v107, v21, v54
    v_dot2_f32_bf16 v55, v111, v21, v55
    v_dot2_f32_bf16 v48, v112, v22, v48
    v_dot2_f32_bf16 v49, v116, v22, v49
    v_dot2_f32_bf16 v50, v113, v22, v50
    v_dot2_f32_bf16 v51, v117, v22, v51
    v_dot2_f32_bf16 v52, v114, v22, v52
    v_dot2_f32_bf16 v53, v118, v22, v53
    v_dot2_f32_bf16 v54, v115, v22, v54
    v_dot2_f32_bf16 v55, v119, v22, v55
    v_dot2_f32_bf16 v48, v120, v23, v48
    v_dot2_f32_bf16 v49, v124, v23, v49
    v_dot2_f32_bf16 v50, v121, v23, v50
    v_dot2_f32_bf16 v51, v125, v23, v51
    v_dot2_f32_bf16 v52, v122, v23, v52
    v_dot2_f32_bf16 v53, v126, v23, v53
    v_dot2_f32_bf16 v54, v123, v23, v54
    v_dot2_f32_bf16 v55, v127, v23, v55
    v_dot2_f32_bf16 v48, v128, v24, v48
    v_dot2_f32_bf16 v49, v132, v24, v49
    v_dot2_f32_bf16 v50, v129, v24, v50
    v_dot2_f32_bf16 v51, v133, v24, v51
    v_dot2_f32_bf16 v52, v130, v24, v52
    v_dot2_f32_bf16 v53, v134, v24, v53
    v_dot2_f32_bf16 v54, v131, v24, v54
    v_dot2_f32_bf16 v55, v135, v24, v55
    v_dot2_f32_bf16 v48, v136, v25, v48
    v_dot2_f32_bf16 v49, v140, v25, v49
    v_dot2_f32_bf16 v50, v137, v25, v50
    v_dot2_f32_bf16 v51, v141, v25, v51
    v_dot2_f32_bf16 v52, v138, v25, v52
    v_dot2_f32_bf16 v53, v142, v25, v53
    v_dot2_f32_bf16 v54, v139, v25, v54
    v_dot2_f32_bf16 v55, v143, v25, v55
    v_dot2_f32_bf16 v48, v144, v26, v48
    v_dot2_f32_bf16 v49, v148, v26, v49
    v_dot2_f32_bf16 v50, v145, v26, v50
    v_dot2_f32_bf16 v51, v149, v26, v51
    v_dot2_f32_bf16 v52, v146, v26, v52
    v_dot2_f32_bf16 v53, v150, v26, v53
    v_dot2_f32_bf16 v54, v147, v26, v54
    v_dot2_f32_bf16 v55, v151, v26, v55
    v_dot2_f32_bf16 v48, v152, v27, v48
    v_dot2_f32_bf16 v49, v156, v27, v49
    v_dot2_f32_bf16 v50, v153, v27, v50
    v_dot2_f32_bf16 v51, v157, v27, v51
    v_dot2_f32_bf16 v52, v154, v27, v52
    v_dot2_f32_bf16 v53, v158, v27, v53
    v_dot2_f32_bf16 v54, v155, v27, v54
    v_dot2_f32_bf16 v55, v159, v27, v55
    v_dot2_f32_bf16 v48, v160, v28, v48
    v_dot2_f32_bf16 v49, v164, v28, v49
    v_dot2_f32_bf16 v50, v161, v28, v50
    v_dot2_f32_bf16 v51, v165, v28, v51
    v_dot2_f32_bf16 v52, v162, v28, v52
    v_dot2_f32_bf16 v53, v166, v28, v53
    v_dot2_f32_bf16 v54, v163, v28, v54
    v_dot2_f32_bf16 v55, v167, v28, v55
    v_dot2_f32_bf16 v48, v168, v29, v48
    v_dot2_f32_bf16 v49, v172, v29, v49
    v_dot2_f32_bf16 v50, v169, v29, v50
    v_dot2_f32_bf16 v51, v173, v29, v51
    v_dot2_f32_bf16 v52, v170, v29, v52
    v_dot2_f32_bf16 v53, v174, v29, v53
    v_dot2_f32_bf16 v54, v171, v29, v54
    v_dot2_f32_bf16 v55, v175, v29, v55
    v_dot2_f32_bf16 v48, v176, v30, v48
    v_dot2_f32_bf16 v49, v180, v30, v49
    v_dot2_f32_bf16 v50, v177, v30, v50
    v_dot2_f32_bf16 v51, v181, v30, v51
    v_dot2_f32_bf16 v52, v178, v30, v52
    v_dot2_f32_bf16 v53, v182, v30, v53
    v_dot2_f32_bf16 v54, v179, v30, v54
    v_dot2_f32_bf16 v55, v183, v30, v55
    v_dot2_f32_bf16 v48, v184, v31, v48
    v_dot2_f32_bf16 v49, v188, v31, v49
    v_dot2_f32_bf16 v50, v185, v31, v50
    v_dot2_f32_bf16 v51, v189, v31, v51
    v_dot2_f32_bf16 v52, v186, v31, v52
    v_dot2_f32_bf16 v53, v190, v31, v53
    v_dot2_f32_bf16 v54, v187, v31, v54
    v_dot2_f32_bf16 v55, v191, v31, v55
    s_nop 3
    v_permlane32_swap_b32 v48, v52
    v_permlane32_swap_b32 v49, v53
    v_permlane32_swap_b32 v50, v54
    v_permlane32_swap_b32 v51, v55
    v_add_f32 v48, v48, v52
    v_add_f32 v49, v49, v53
    v_add_f32 v50, v50, v54
    v_add_f32 v51, v51, v55
    s_nop 1
    v_permlane16_swap_b32 v48, v50
    v_permlane16_swap_b32 v49, v51
    v_add_f32 v48, v48, v50
    v_add_f32 v49, v49, v51
    s_nop 1
    v_add_f32_dpp v48, v48, v48 quad_perm:[1,0,3,2] row_mask:0xf bank_mask:0xf
    v_add_f32_dpp v49, v49, v49 quad_perm:[1,0,3,2] row_mask:0xf bank_mask:0xf
    s_nop 1
    v_add_f32_dpp v48, v48, v48 quad_perm:[2,3,0,1] row_mask:0xf bank_mask:0xf
    v_add_f32_dpp v49, v49, v49 quad_perm:[2,3,0,1] row_mask:0xf bank_mask:0xf
    s_nop 1
    v_add_f32_dpp v48, v48, v48 row_half_mirror row_mask:0xf bank_mask:0xf
    v_add_f32_dpp v49, v49, v49 row_half_mirror row_mask:0xf bank_mask:0xf
    s_nop 1
    v_add_f32_dpp v48, v48, v48 row_mirror row_mask:0xf bank_mask:0xf
    v_add_f32_dpp v49, v49, v49 row_mirror row_mask:0xf bank_mask:0xf
    v_lshrrev_b32 v4, 1, v1
    s_sub_u32 s65, s60, 2
    s_lshl_b32 s65, s65, 5
    v_add_u32 v4, s65, v4
    s_mov_b32 exec_lo, 0x00010001
    s_mov_b32 exec_hi, 0x00010001
    ds_write_b64 v4, v[48:49] offset:5184
    s_mov_b64 exec, -1
    s_waitcnt lgkmcnt(0)
    s_barrier
    s_cmp_lg_u32 s60, 2
    s_cbranch_scc1 L_done
    v_lshlrev_b32 v4, 3, v1
    s_mov_b64 exec, 15
    ds_read_b64 v[16:17], v4 offset:5184
    ds_read_b64 v[18:19], v4 offset:5216
    s_mov_b32 s24, s54
    s_mov_b32 s25, s55
    s_mov_b32 s26, 896
    s_mov_b32 s27, 0x20000
    s_waitcnt lgkmcnt(0)
    v_add_f32 v16, v16, v18
    v_cvt_pk_bf16_f32 v16, v16, v16
    v_and_b32 v16, 0xffff0000, v16
    v_mul_f32 v16, v253, v16
    v_cvt_pk_bf16_f32 v16, v16, v16
    v_and_b32 v16, 0xffff0000, v16
    v_add_f32 v16, v16, v250
    v_add_f32 v17, v17, v19
    v_cvt_pk_bf16_f32 v17, v17, v17
    v_and_b32 v17, 0xffff0000, v17
    v_mul_f32 v17, v253, v17
    v_cvt_pk_bf16_f32 v17, v17, v17
    v_and_b32 v17, 0xffff0000, v17
    v_add_f32 v17, v17, v251
    v_cvt_pk_bf16_f32 v16, v16, v17
    v_lshlrev_b32 v4, 2, v1
    buffer_store_dword v16, v4, s[24:27], s86 offen
L_done:
L_exit:
    s_endpgm
L_fallback:
    s_waitcnt vmcnt(0)
    v_and_b32 v4, 7, v1
    v_lshrrev_b32 v5, 3, v1
    v_and_b32 v5, 3, v5
    v_lshl_add_u32 v4, v5, 6, v4
    v_lshlrev_b32 v4, 12, v4
    s_lshl_b32 s65, s71, 2
    s_add_u32 s65, s65, 0
    s_lshl_b32 s65, s65, 15
    s_add_u32 s65, s65, 131072
    buffer_load_dwordx2 v[192:193], v4, s[12:15], s65 offen offset:2048 sc1
    s_waitcnt vmcnt(0)
    v_mov_b32 v194, v192
    s_nop 1
    v_max_f32_dpp v194, v194, v194 quad_perm:[1,0,3,2] row_mask:0xf bank_mask:0xf
    s_nop 1
    v_max_f32_dpp v194, v194, v194 quad_perm:[2,3,0,1] row_mask:0xf bank_mask:0xf
    s_nop 1
    v_max_f32_dpp v194, v194, v194 row_half_mirror row_mask:0xf bank_mask:0xf
    s_nop 1
    v_max_f32_dpp v194, v194, v194 row_mirror row_mask:0xf bank_mask:0xf
    v_mov_b32 v5, v194
    s_nop 1
    v_permlane16_swap_b32 v194, v5
    v_max_f32 v194, v194, v5
    v_mov_b32 v5, v194
    s_nop 1
    v_permlane32_swap_b32 v194, v5
    v_max_f32 v194, v194, v5
    v_sub_f32 v192, v192, v194
    v_exp_f32 v192, v192
    s_nop 0
    v_mul_f32 v193, v192, v193
    s_nop 1
    v_add_f32_dpp v193, v193, v193 quad_perm:[1,0,3,2] row_mask:0xf bank_mask:0xf
    s_nop 1
    v_add_f32_dpp v193, v193, v193 quad_perm:[2,3,0,1] row_mask:0xf bank_mask:0xf
    s_nop 1
    v_add_f32_dpp v193, v193, v193 row_half_mirror row_mask:0xf bank_mask:0xf
    s_nop 1
    v_add_f32_dpp v193, v193, v193 row_mirror row_mask:0xf bank_mask:0xf
    v_mov_b32 v5, v193
    s_nop 1
    v_permlane16_swap_b32 v193, v5
    v_add_f32 v193, v193, v5
    v_mov_b32 v5, v193
    s_nop 1
    v_permlane32_swap_b32 v193, v5
    v_add_f32 v193, v193, v5
    v_mul_f32 v56, 0.5, v193
    v_mov_b32 v16, 0
    v_mov_b32 v17, 0
    v_mov_b32 v18, 0
    v_mov_b32 v19, 0
    s_mov_b32 s66, 0
L_fb0:
    s_and_b32 s72, s66, 7
    s_lshr_b32 s73, s66, 3
    s_lshl_b32 s73, s73, 6
    s_or_b32 s72, s72, s73
    s_lshl_b32 s72, s72, 12
    s_add_u32 s72, s72, s65
    buffer_load_dword v196, v14, s[12:15], s72 offen offset:0 sc1
    buffer_load_dword v197, v14, s[12:15], s72 offen offset:256 sc1
    buffer_load_dword v198, v14, s[12:15], s72 offen offset:512 sc1
    buffer_load_dword v199, v14, s[12:15], s72 offen offset:768 sc1
    v_readlane_b32 s73, v192, s66
    s_nop 1
    s_waitcnt vmcnt(0)
    v_fma_f32 v16, s73, v196, v16
    v_fma_f32 v17, s73, v197, v17
    v_fma_f32 v18, s73, v198, v18
    v_fma_f32 v19, s73, v199, v19
    s_add_u32 s66, s66, 1
    s_cmp_lt_u32 s66, 32
    s_cbranch_scc1 L_fb0
    s_lshl_b32 s65, s71, 2
    s_add_u32 s65, s65, 0
    s_lshl_b32 s65, s65, 15
    s_add_u32 s65, s65, 131072
    buffer_load_dwordx2 v[192:193], v4, s[12:15], s65 offen offset:2056 sc1
    s_waitcnt vmcnt(0)
    v_mov_b32 v194, v192
    s_nop 1
    v_max_f32_dpp v194, v194, v194 quad_perm:[1,0,3,2] row_mask:0xf bank_mask:0xf
    s_nop 1
    v_max_f32_dpp v194, v194, v194 quad_perm:[2,3,0,1] row_mask:0xf bank_mask:0xf
    s_nop 1
    v_max_f32_dpp v194, v194, v194 row_half_mirror row_mask:0xf bank_mask:0xf
    s_nop 1
    v_max_f32_dpp v194, v194, v194 row_mirror row_mask:0xf bank_mask:0xf
    v_mov_b32 v5, v194
    s_nop 1
    v_permlane16_swap_b32 v194, v5
    v_max_f32 v194, v194, v5
    v_mov_b32 v5, v194
    s_nop 1
    v_permlane32_swap_b32 v194, v5
    v_max_f32 v194, v194, v5
    v_sub_f32 v192, v192, v194
    v_exp_f32 v192, v192
    s_nop 0
    v_mul_f32 v193, v192, v193
    s_nop 1
    v_add_f32_dpp v193, v193, v193 quad_perm:[1,0,3,2] row_mask:0xf bank_mask:0xf
    s_nop 1
    v_add_f32_dpp v193, v193, v193 quad_perm:[2,3,0,1] row_mask:0xf bank_mask:0xf
    s_nop 1
    v_add_f32_dpp v193, v193, v193 row_half_mirror row_mask:0xf bank_mask:0xf
    s_nop 1
    v_add_f32_dpp v193, v193, v193 row_mirror row_mask:0xf bank_mask:0xf
    v_mov_b32 v5, v193
    s_nop 1
    v_permlane16_swap_b32 v193, v5
    v_add_f32 v193, v193, v5
    v_mov_b32 v5, v193
    s_nop 1
    v_permlane32_swap_b32 v193, v5
    v_add_f32 v193, v193, v5
    v_mul_f32 v57, 0.5, v193
    v_mov_b32 v20, 0
    v_mov_b32 v21, 0
    v_mov_b32 v22, 0
    v_mov_b32 v23, 0
    s_mov_b32 s66, 0
L_fb1:
    s_and_b32 s72, s66, 7
    s_lshr_b32 s73, s66, 3
    s_lshl_b32 s73, s73, 6
    s_or_b32 s72, s72, s73
    s_lshl_b32 s72, s72, 12
    s_add_u32 s72, s72, s65
    buffer_load_dword v196, v14, s[12:15], s72 offen offset:1024 sc1
    buffer_load_dword v197, v14, s[12:15], s72 offen offset:1280 sc1
    buffer_load_dword v198, v14, s[12:15], s72 offen offset:1536 sc1
    buffer_load_dword v199, v14, s[12:15], s72 offen offset:1792 sc1
    v_readlane_b32 s73, v192, s66
    s_nop 1
    s_waitcnt vmcnt(0)
    v_fma_f32 v20, s73, v196, v20
    v_fma_f32 v21, s73, v197, v21
    v_fma_f32 v22, s73, v198, v22
    v_fma_f32 v23, s73, v199, v23
    s_add_u32 s66, s66, 1
    s_cmp_lt_u32 s66, 32
    s_cbranch_scc1 L_fb1
    s_lshl_b32 s65, s71, 2
    s_add_u32 s65, s65, 1
    s_lshl_b32 s65, s65, 15
    s_add_u32 s65, s65, 131072
    buffer_load_dwordx2 v[192:193], v4, s[12:15], s65 offen offset:2048 sc1
    s_waitcnt vmcnt(0)
    v_mov_b32 v194, v192
    s_nop 1
    v_max_f32_dpp v194, v194, v194 quad_perm:[1,0,3,2] row_mask:0xf bank_mask:0xf
    s_nop 1
    v_max_f32_dpp v194, v194, v194 quad_perm:[2,3,0,1] row_mask:0xf bank_mask:0xf
    s_nop 1
    v_max_f32_dpp v194, v194, v194 row_half_mirror row_mask:0xf bank_mask:0xf
    s_nop 1
    v_max_f32_dpp v194, v194, v194 row_mirror row_mask:0xf bank_mask:0xf
    v_mov_b32 v5, v194
    s_nop 1
    v_permlane16_swap_b32 v194, v5
    v_max_f32 v194, v194, v5
    v_mov_b32 v5, v194
    s_nop 1
    v_permlane32_swap_b32 v194, v5
    v_max_f32 v194, v194, v5
    v_sub_f32 v192, v192, v194
    v_exp_f32 v192, v192
    s_nop 0
    v_mul_f32 v193, v192, v193
    s_nop 1
    v_add_f32_dpp v193, v193, v193 quad_perm:[1,0,3,2] row_mask:0xf bank_mask:0xf
    s_nop 1
    v_add_f32_dpp v193, v193, v193 quad_perm:[2,3,0,1] row_mask:0xf bank_mask:0xf
    s_nop 1
    v_add_f32_dpp v193, v193, v193 row_half_mirror row_mask:0xf bank_mask:0xf
    s_nop 1
    v_add_f32_dpp v193, v193, v193 row_mirror row_mask:0xf bank_mask:0xf
    v_mov_b32 v5, v193
    s_nop 1
    v_permlane16_swap_b32 v193, v5
    v_add_f32 v193, v193, v5
    v_mov_b32 v5, v193
    s_nop 1
    v_permlane32_swap_b32 v193, v5
    v_add_f32 v193, v193, v5
    v_mul_f32 v58, 0.5, v193
    v_mov_b32 v24, 0
    v_mov_b32 v25, 0
    v_mov_b32 v26, 0
    v_mov_b32 v27, 0
    s_mov_b32 s66, 0
L_fb2:
    s_and_b32 s72, s66, 7
    s_lshr_b32 s73, s66, 3
    s_lshl_b32 s73, s73, 6
    s_or_b32 s72, s72, s73
    s_lshl_b32 s72, s72, 12
    s_add_u32 s72, s72, s65
    buffer_load_dword v196, v14, s[12:15], s72 offen offset:0 sc1
    buffer_load_dword v197, v14, s[12:15], s72 offen offset:256 sc1
    buffer_load_dword v198, v14, s[12:15], s72 offen offset:512 sc1
    buffer_load_dword v199, v14, s[12:15], s72 offen offset:768 sc1
    v_readlane_b32 s73, v192, s66
    s_nop 1
    s_waitcnt vmcnt(0)
    v_fma_f32 v24, s73, v196, v24
    v_fma_f32 v25, s73, v197, v25
    v_fma_f32 v26, s73, v198, v26
    v_fma_f32 v27, s73, v199, v27
    s_add_u32 s66, s66, 1
    s_cmp_lt_u32 s66, 32
    s_cbranch_scc1 L_fb2
    s_lshl_b32 s65, s71, 2
    s_add_u32 s65, s65, 1
    s_lshl_b32 s65, s65, 15
    s_add_u32 s65, s65, 131072
    buffer_load_dwordx2 v[192:193], v4, s[12:15], s65 offen offset:2056 sc1
    s_waitcnt vmcnt(0)
    v_mov_b32 v194, v192
    s_nop 1
    v_max_f32_dpp v194, v194, v194 quad_perm:[1,0,3,2] row_mask:0xf bank_mask:0xf
    s_nop 1
    v_max_f32_dpp v194, v194, v194 quad_perm:[2,3,0,1] row_mask:0xf bank_mask:0xf
    s_nop 1
    v_max_f32_dpp v194, v194, v194 row_half_mirror row_mask:0xf bank_mask:0xf
    s_nop 1
    v_max_f32_dpp v194, v194, v194 row_mirror row_mask:0xf bank_mask:0xf
    v_mov_b32 v5, v194
    s_nop 1
    v_permlane16_swap_b32 v194, v5
    v_max_f32 v194, v194, v5
    v_mov_b32 v5, v194
    s_nop 1
    v_permlane32_swap_b32 v194, v5
    v_max_f32 v194, v194, v5
    v_sub_f32 v192, v192, v194
    v_exp_f32 v192, v192
    s_nop 0
    v_mul_f32 v193, v192, v193
    s_nop 1
    v_add_f32_dpp v193, v193, v193 quad_perm:[1,0,3,2] row_mask:0xf bank_mask:0xf
    s_nop 1
    v_add_f32_dpp v193, v193, v193 quad_perm:[2,3,0,1] row_mask:0xf bank_mask:0xf
    s_nop 1
    v_add_f32_dpp v193, v193, v193 row_half_mirror row_mask:0xf bank_mask:0xf
    s_nop 1
    v_add_f32_dpp v193, v193, v193 row_mirror row_mask:0xf bank_mask:0xf
    v_mov_b32 v5, v193
    s_nop 1
    v_permlane16_swap_b32 v193, v5
    v_add_f32 v193, v193, v5
    v_mov_b32 v5, v193
    s_nop 1
    v_permlane32_swap_b32 v193, v5
    v_add_f32 v193, v193, v5
    v_mul_f32 v59, 0.5, v193
    v_mov_b32 v28, 0
    v_mov_b32 v29, 0
    v_mov_b32 v30, 0
    v_mov_b32 v31, 0
    s_mov_b32 s66, 0
L_fb3:
    s_and_b32 s72, s66, 7
    s_lshr_b32 s73, s66, 3
    s_lshl_b32 s73, s73, 6
    s_or_b32 s72, s72, s73
    s_lshl_b32 s72, s72, 12
    s_add_u32 s72, s72, s65
    buffer_load_dword v196, v14, s[12:15], s72 offen offset:1024 sc1
    buffer_load_dword v197, v14, s[12:15], s72 offen offset:1280 sc1
    buffer_load_dword v198, v14, s[12:15], s72 offen offset:1536 sc1
    buffer_load_dword v199, v14, s[12:15], s72 offen offset:1792 sc1
    v_readlane_b32 s73, v192, s66
    s_nop 1
    s_waitcnt vmcnt(0)
    v_fma_f32 v28, s73, v196, v28
    v_fma_f32 v29, s73, v197, v29
    v_fma_f32 v30, s73, v198, v30
    v_fma_f32 v31, s73, v199, v31
    s_add_u32 s66, s66, 1
    s_cmp_lt_u32 s66, 32
    s_cbranch_scc1 L_fb3
    s_lshl_b32 s65, s71, 2
    s_add_u32 s65, s65, 2
    s_lshl_b32 s65, s65, 15
    s_add_u32 s65, s65, 131072
    buffer_load_dwordx2 v[192:193], v4, s[12:15], s65 offen offset:2048 sc1
    s_waitcnt vmcnt(0)
    v_mov_b32 v194, v192
    s_nop 1
    v_max_f32_dpp v194, v194, v194 quad_perm:[1,0,3,2] row_mask:0xf bank_mask:0xf
    s_nop 1
    v_max_f32_dpp v194, v194, v194 quad_perm:[2,3,0,1] row_mask:0xf bank_mask:0xf
    s_nop 1
    v_max_f32_dpp v194, v194, v194 row_half_mirror row_mask:0xf bank_mask:0xf
    s_nop 1
    v_max_f32_dpp v194, v194, v194 row_mirror row_mask:0xf bank_mask:0xf
    v_mov_b32 v5, v194
    s_nop 1
    v_permlane16_swap_b32 v194, v5
    v_max_f32 v194, v194, v5
    v_mov_b32 v5, v194
    s_nop 1
    v_permlane32_swap_b32 v194, v5
    v_max_f32 v194, v194, v5
    v_sub_f32 v192, v192, v194
    v_exp_f32 v192, v192
    s_nop 0
    v_mul_f32 v193, v192, v193
    s_nop 1
    v_add_f32_dpp v193, v193, v193 quad_perm:[1,0,3,2] row_mask:0xf bank_mask:0xf
    s_nop 1
    v_add_f32_dpp v193, v193, v193 quad_perm:[2,3,0,1] row_mask:0xf bank_mask:0xf
    s_nop 1
    v_add_f32_dpp v193, v193, v193 row_half_mirror row_mask:0xf bank_mask:0xf
    s_nop 1
    v_add_f32_dpp v193, v193, v193 row_mirror row_mask:0xf bank_mask:0xf
    v_mov_b32 v5, v193
    s_nop 1
    v_permlane16_swap_b32 v193, v5
    v_add_f32 v193, v193, v5
    v_mov_b32 v5, v193
    s_nop 1
    v_permlane32_swap_b32 v193, v5
    v_add_f32 v193, v193, v5
    v_mul_f32 v60, 0.5, v193
    v_mov_b32 v32, 0
    v_mov_b32 v33, 0
    v_mov_b32 v34, 0
    v_mov_b32 v35, 0
    s_mov_b32 s66, 0
L_fb4:
    s_and_b32 s72, s66, 7
    s_lshr_b32 s73, s66, 3
    s_lshl_b32 s73, s73, 6
    s_or_b32 s72, s72, s73
    s_lshl_b32 s72, s72, 12
    s_add_u32 s72, s72, s65
    buffer_load_dword v196, v14, s[12:15], s72 offen offset:0 sc1
    buffer_load_dword v197, v14, s[12:15], s72 offen offset:256 sc1
    buffer_load_dword v198, v14, s[12:15], s72 offen offset:512 sc1
    buffer_load_dword v199, v14, s[12:15], s72 offen offset:768 sc1
    v_readlane_b32 s73, v192, s66
    s_nop 1
    s_waitcnt vmcnt(0)
    v_fma_f32 v32, s73, v196, v32
    v_fma_f32 v33, s73, v197, v33
    v_fma_f32 v34, s73, v198, v34
    v_fma_f32 v35, s73, v199, v35
    s_add_u32 s66, s66, 1
    s_cmp_lt_u32 s66, 32
    s_cbranch_scc1 L_fb4
    s_lshl_b32 s65, s71, 2
    s_add_u32 s65, s65, 2
    s_lshl_b32 s65, s65, 15
    s_add_u32 s65, s65, 131072
    buffer_load_dwordx2 v[192:193], v4, s[12:15], s65 offen offset:2056 sc1
    s_waitcnt vmcnt(0)
    v_mov_b32 v194, v192
    s_nop 1
    v_max_f32_dpp v194, v194, v194 quad_perm:[1,0,3,2] row_mask:0xf bank_mask:0xf
    s_nop 1
    v_max_f32_dpp v194, v194, v194 quad_perm:[2,3,0,1] row_mask:0xf bank_mask:0xf
    s_nop 1
    v_max_f32_dpp v194, v194, v194 row_half_mirror row_mask:0xf bank_mask:0xf
    s_nop 1
    v_max_f32_dpp v194, v194, v194 row_mirror row_mask:0xf bank_mask:0xf
    v_mov_b32 v5, v194
    s_nop 1
    v_permlane16_swap_b32 v194, v5
    v_max_f32 v194, v194, v5
    v_mov_b32 v5, v194
    s_nop 1
    v_permlane32_swap_b32 v194, v5
    v_max_f32 v194, v194, v5
    v_sub_f32 v192, v192, v194
    v_exp_f32 v192, v192
    s_nop 0
    v_mul_f32 v193, v192, v193
    s_nop 1
    v_add_f32_dpp v193, v193, v193 quad_perm:[1,0,3,2] row_mask:0xf bank_mask:0xf
    s_nop 1
    v_add_f32_dpp v193, v193, v193 quad_perm:[2,3,0,1] row_mask:0xf bank_mask:0xf
    s_nop 1
    v_add_f32_dpp v193, v193, v193 row_half_mirror row_mask:0xf bank_mask:0xf
    s_nop 1
    v_add_f32_dpp v193, v193, v193 row_mirror row_mask:0xf bank_mask:0xf
    v_mov_b32 v5, v193
    s_nop 1
    v_permlane16_swap_b32 v193, v5
    v_add_f32 v193, v193, v5
    v_mov_b32 v5, v193
    s_nop 1
    v_permlane32_swap_b32 v193, v5
    v_add_f32 v193, v193, v5
    v_mul_f32 v61, 0.5, v193
    v_mov_b32 v36, 0
    v_mov_b32 v37, 0
    v_mov_b32 v38, 0
    v_mov_b32 v39, 0
    s_mov_b32 s66, 0
L_fb5:
    s_and_b32 s72, s66, 7
    s_lshr_b32 s73, s66, 3
    s_lshl_b32 s73, s73, 6
    s_or_b32 s72, s72, s73
    s_lshl_b32 s72, s72, 12
    s_add_u32 s72, s72, s65
    buffer_load_dword v196, v14, s[12:15], s72 offen offset:1024 sc1
    buffer_load_dword v197, v14, s[12:15], s72 offen offset:1280 sc1
    buffer_load_dword v198, v14, s[12:15], s72 offen offset:1536 sc1
    buffer_load_dword v199, v14, s[12:15], s72 offen offset:1792 sc1
    v_readlane_b32 s73, v192, s66
    s_nop 1
    s_waitcnt vmcnt(0)
    v_fma_f32 v36, s73, v196, v36
    v_fma_f32 v37, s73, v197, v37
    v_fma_f32 v38, s73, v198, v38
    v_fma_f32 v39, s73, v199, v39
    s_add_u32 s66, s66, 1
    s_cmp_lt_u32 s66, 32
    s_cbranch_scc1 L_fb5
    s_lshl_b32 s65, s71, 2
    s_add_u32 s65, s65, 3
    s_lshl_b32 s65, s65, 15
    s_add_u32 s65, s65, 131072
    buffer_load_dwordx2 v[192:193], v4, s[12:15], s65 offen offset:2048 sc1
    s_waitcnt vmcnt(0)
    v_mov_b32 v194, v192
    s_nop 1
    v_max_f32_dpp v194, v194, v194 quad_perm:[1,0,3,2] row_mask:0xf bank_mask:0xf
    s_nop 1
    v_max_f32_dpp v194, v194, v194 quad_perm:[2,3,0,1] row_mask:0xf bank_mask:0xf
    s_nop 1
    v_max_f32_dpp v194, v194, v194 row_half_mirror row_mask:0xf bank_mask:0xf
    s_nop 1
    v_max_f32_dpp v194, v194, v194 row_mirror row_mask:0xf bank_mask:0xf
    v_mov_b32 v5, v194
    s_nop 1
    v_permlane16_swap_b32 v194, v5
    v_max_f32 v194, v194, v5
    v_mov_b32 v5, v194
    s_nop 1
    v_permlane32_swap_b32 v194, v5
    v_max_f32 v194, v194, v5
    v_sub_f32 v192, v192, v194
    v_exp_f32 v192, v192
    s_nop 0
    v_mul_f32 v193, v192, v193
    s_nop 1
    v_add_f32_dpp v193, v193, v193 quad_perm:[1,0,3,2] row_mask:0xf bank_mask:0xf
    s_nop 1
    v_add_f32_dpp v193, v193, v193 quad_perm:[2,3,0,1] row_mask:0xf bank_mask:0xf
    s_nop 1
    v_add_f32_dpp v193, v193, v193 row_half_mirror row_mask:0xf bank_mask:0xf
    s_nop 1
    v_add_f32_dpp v193, v193, v193 row_mirror row_mask:0xf bank_mask:0xf
    v_mov_b32 v5, v193
    s_nop 1
    v_permlane16_swap_b32 v193, v5
    v_add_f32 v193, v193, v5
    v_mov_b32 v5, v193
    s_nop 1
    v_permlane32_swap_b32 v193, v5
    v_add_f32 v193, v193, v5
    v_mul_f32 v62, 0.5, v193
    v_mov_b32 v40, 0
    v_mov_b32 v41, 0
    v_mov_b32 v42, 0
    v_mov_b32 v43, 0
    s_mov_b32 s66, 0
L_fb6:
    s_and_b32 s72, s66, 7
    s_lshr_b32 s73, s66, 3
    s_lshl_b32 s73, s73, 6
    s_or_b32 s72, s72, s73
    s_lshl_b32 s72, s72, 12
    s_add_u32 s72, s72, s65
    buffer_load_dword v196, v14, s[12:15], s72 offen offset:0 sc1
    buffer_load_dword v197, v14, s[12:15], s72 offen offset:256 sc1
    buffer_load_dword v198, v14, s[12:15], s72 offen offset:512 sc1
    buffer_load_dword v199, v14, s[12:15], s72 offen offset:768 sc1
    v_readlane_b32 s73, v192, s66
    s_nop 1
    s_waitcnt vmcnt(0)
    v_fma_f32 v40, s73, v196, v40
    v_fma_f32 v41, s73, v197, v41
    v_fma_f32 v42, s73, v198, v42
    v_fma_f32 v43, s73, v199, v43
    s_add_u32 s66, s66, 1
    s_cmp_lt_u32 s66, 32
    s_cbranch_scc1 L_fb6
    s_lshl_b32 s65, s71, 2
    s_add_u32 s65, s65, 3
    s_lshl_b32 s65, s65, 15
    s_add_u32 s65, s65, 131072
    buffer_load_dwordx2 v[192:193], v4, s[12:15], s65 offen offset:2056 sc1
    s_waitcnt vmcnt(0)
    v_mov_b32 v194, v192
    s_nop 1
    v_max_f32_dpp v194, v194, v194 quad_perm:[1,0,3,2] row_mask:0xf bank_mask:0xf
    s_nop 1
    v_max_f32_dpp v194, v194, v194 quad_perm:[2,3,0,1] row_mask:0xf bank_mask:0xf
    s_nop 1
    v_max_f32_dpp v194, v194, v194 row_half_mirror row_mask:0xf bank_mask:0xf
    s_nop 1
    v_max_f32_dpp v194, v194, v194 row_mirror row_mask:0xf bank_mask:0xf
    v_mov_b32 v5, v194
    s_nop 1
    v_permlane16_swap_b32 v194, v5
    v_max_f32 v194, v194, v5
    v_mov_b32 v5, v194
    s_nop 1
    v_permlane32_swap_b32 v194, v5
    v_max_f32 v194, v194, v5
    v_sub_f32 v192, v192, v194
    v_exp_f32 v192, v192
    s_nop 0
    v_mul_f32 v193, v192, v193
    s_nop 1
    v_add_f32_dpp v193, v193, v193 quad_perm:[1,0,3,2] row_mask:0xf bank_mask:0xf
    s_nop 1
    v_add_f32_dpp v193, v193, v193 quad_perm:[2,3,0,1] row_mask:0xf bank_mask:0xf
    s_nop 1
    v_add_f32_dpp v193, v193, v193 row_half_mirror row_mask:0xf bank_mask:0xf
    s_nop 1
    v_add_f32_dpp v193, v193, v193 row_mirror row_mask:0xf bank_mask:0xf
    v_mov_b32 v5, v193
    s_nop 1
    v_permlane16_swap_b32 v193, v5
    v_add_f32 v193, v193, v5
    v_mov_b32 v5, v193
    s_nop 1
    v_permlane32_swap_b32 v193, v5
    v_add_f32 v193, v193, v5
    v_mul_f32 v63, 0.5, v193
    v_mov_b32 v44, 0
    v_mov_b32 v45, 0
    v_mov_b32 v46, 0
    v_mov_b32 v47, 0
    s_mov_b32 s66, 0
L_fb7:
    s_and_b32 s72, s66, 7
    s_lshr_b32 s73, s66, 3
    s_lshl_b32 s73, s73, 6
    s_or_b32 s72, s72, s73
    s_lshl_b32 s72, s72, 12
    s_add_u32 s72, s72, s65
    buffer_load_dword v196, v14, s[12:15], s72 offen offset:1024 sc1
    buffer_load_dword v197, v14, s[12:15], s72 offen offset:1280 sc1
    buffer_load_dword v198, v14, s[12:15], s72 offen offset:1536 sc1
    buffer_load_dword v199, v14, s[12:15], s72 offen offset:1792 sc1
    v_readlane_b32 s73, v192, s66
    s_nop 1
    s_waitcnt vmcnt(0)
    v_fma_f32 v44, s73, v196, v44
    v_fma_f32 v45, s73, v197, v45
    v_fma_f32 v46, s73, v198, v46
    v_fma_f32 v47, s73, v199, v47
    s_add_u32 s66, s66, 1
    s_cmp_lt_u32 s66, 32
    s_cbranch_scc1 L_fb7
    s_branch L_fast
.section .rodata,"a"
.p2align 6
.amdhsa_kernel gated_mix__gqa_block_cached__dense_activation_gelu__decode_kernel
  .amdhsa_next_free_vgpr 512
  .amdhsa_next_free_sgpr 102
  .amdhsa_accum_offset 256
  .amdhsa_group_segment_fixed_size 0
  .amdhsa_kernarg_size 112
  .amdhsa_user_sgpr_count 2
  .amdhsa_user_sgpr_kernarg_segment_ptr 1
  .amdhsa_system_sgpr_workgroup_id_x 1
  .amdhsa_float_denorm_mode_32 3
.end_amdhsa_kernel
```
